```python
import torch

def _softmax(x, axis=-1):
    return torch.softmax(x, dim=axis)
def _gelu(x):
    return torch.nn.functional.gelu(x, approximate="tanh")
def _silu(x):
    return torch.nn.functional.silu(x)
def _sigmoid(x):
    return torch.sigmoid(x)
def _layernorm(x, axis=-1, eps=1e-5):
    m = x.mean(dim=axis, keepdim=True)
    v = x.var(dim=axis, keepdim=True, unbiased=False)
    return (x - m) / torch.sqrt(v + eps)
def _scatter_add(tgt, idx, src, axis=0):
    return tgt.clone().index_add_(axis, idx, src)
def _segment_sum(src, seg, n):
    out = torch.zeros((n,) + src.shape[1:], dtype=src.dtype)
    return out.index_add_(0, seg, src)
def _pad(x, pw):
    flat = tuple(v for pair in reversed(pw) for v in pair)
    return torch.nn.functional.pad(x, flat)

kernel_name = 'standalone__mha_block__prompt'

def setup_inputs():

    _w = (lambda a: (lambda t: t.to(torch.bfloat16) if t.is_floating_point() else t)(torch.as_tensor(a)))
    B, S, D, H = 1, 2048, 640, 32
    return {
        "x": _w((lambda *s: torch.randn(*s, dtype=torch.bfloat16) * 0.2)(B, S, D)),
        "wqkv": _w((lambda *s: torch.randn(*s, dtype=torch.bfloat16) * 0.2)(D, 3 * D)),
        "wo": _w((lambda *s: torch.randn(*s, dtype=torch.bfloat16) * 0.05)(D, D)),
    }

def reference(x, wqkv, wo):
    B, S, D = x.shape
    H = 32
    Dh = D // H
    qkv = (lambda x, *d: x.permute(*d))((x @ wqkv).reshape(B, S, 3, H, Dh), 2, 0, 3, 1, 4)
    q, k, v = qkv[0], qkv[1], qkv[2]
    scores = torch.einsum("bhqd,bhkd->bhqk", q, k) * (Dh ** -0.5)
    p = _softmax(scores, axis=-1)
    o = torch.einsum("bhqk,bhkd->bhqd", p, v)
    return (lambda x, *d: x.permute(*d))(o, 0, 2, 1, 3).reshape(B, S, D) @ wo
```

```asm
; @launch kernel=mha_qkv_kernel grid=(240,1,1) block=(256,1,1) lds=131072
; @launch kernel=mha_attn_kernel grid=(256,1,1) block=(512,1,1) lds=163840
; @launch kernel=mha_oproj_kernel grid=(80,1,1) block=(256,1,1) lds=131072
.amdgcn_target "amdgcn-amd-amdhsa--gfx950"
.text
.globl mha_qkv_kernel
.p2align 8
.type mha_qkv_kernel,@function
mha_qkv_kernel:
    s_cmp_ge_u32 s2, 240
    s_cbranch_scc1 L_mha_qkv_kernel_end
    s_load_dwordx4 s[4:7], s[0:1], 0
    s_load_dwordx4 s[8:11], s[0:1], 16
    s_load_dwordx2 s[26:27], s[0:1], 40
    v_and_b32 v1, 63, v0
    v_lshrrev_b32 v20, 6, v0
    s_nop 0
    v_readfirstlane_b32 s20, v20
    s_and_b32 s21, s2, 7
    s_lshr_b32 s22, s2, 3
    s_and_b32 s23, s22, 1
    s_lshl_b32 s21, s21, 1
    s_add_u32 s24, s21, s23
    s_lshr_b32 s25, s22, 1
    s_waitcnt lgkmcnt(0)
    s_mov_b32 s12, s4
    s_mov_b32 s13, s5
    s_mov_b32 s14, 2621440
    s_mov_b32 s15, 0x00020000
    s_mov_b32 s16, s6
    s_mov_b32 s17, s7
    s_mov_b32 s18, 2457600
    s_mov_b32 s19, 0x00020000
    s_mov_b32 s44, s26
    s_mov_b32 s45, s27
    s_mov_b32 s46, 268435456
    s_mov_b32 s47, 0x00020000
    v_lshrrev_b32 v20, 3, v1
    v_mul_u32_u24 v20, 1280, v20
    v_and_b32 v21, 7, v1
    v_lshrrev_b32 v22, 4, v1
    v_xor_b32 v21, v21, v22
    v_lshlrev_b32 v23, 4, v21
    v_add_u32 v2, v20, v23
    v_xor_b32 v21, 4, v21
    v_lshlrev_b32 v23, 4, v21
    v_add_u32 v3, v20, v23
    v_lshrrev_b32 v20, 4, v1
    v_mul_u32_u24 v21, 3840, v20
    v_and_b32 v22, 15, v1
    v_lshlrev_b32 v20, 2, v20
    v_xor_b32 v22, v22, v20
    v_lshlrev_b32 v22, 4, v22
    v_add_u32 v4, v21, v22
    s_lshl_b32 s30, s24, 7
    s_lshl_b32 s32, s20, 5
    s_add_u32 s30, s30, s32
    s_mul_i32 s30, s30, 1280
    s_lshl_b32 s31, s20, 4
    s_mul_i32 s31, s31, 3840
    s_lshl_b32 s32, s25, 8
    s_add_u32 s31, s31, s32
    s_lshl_b32 s33, s20, 12
    s_lshl_b32 s34, s20, 12
    s_add_u32 m0, s33, 0
    s_add_u32 s35, s30, 0
    buffer_load_dwordx4 v2, s[12:15], s35 offen lds
    s_add_u32 m0, s33, 1024
    s_add_u32 s35, s30, 10240
    buffer_load_dwordx4 v3, s[12:15], s35 offen lds
    s_add_u32 m0, s33, 2048
    s_add_u32 s35, s30, 20480
    buffer_load_dwordx4 v2, s[12:15], s35 offen lds
    s_add_u32 m0, s33, 3072
    s_add_u32 s35, s30, 30720
    buffer_load_dwordx4 v3, s[12:15], s35 offen lds
    s_add_u32 m0, s34, 16384
    s_add_u32 s35, s31, 0
    buffer_load_dwordx4 v4, s[16:19], s35 offen lds
    s_add_u32 m0, s34, 17408
    s_add_u32 s35, s31, 15360
    buffer_load_dwordx4 v4, s[16:19], s35 offen lds
    s_add_u32 m0, s34, 18432
    s_add_u32 s35, s31, 30720
    buffer_load_dwordx4 v4, s[16:19], s35 offen lds
    s_add_u32 m0, s34, 19456
    s_add_u32 s35, s31, 46080
    buffer_load_dwordx4 v4, s[16:19], s35 offen lds
    s_add_u32 m0, s33, 32768
    s_add_u32 s35, s30, 128
    buffer_load_dwordx4 v2, s[12:15], s35 offen lds
    s_add_u32 m0, s33, 33792
    s_add_u32 s35, s30, 10368
    buffer_load_dwordx4 v3, s[12:15], s35 offen lds
    s_add_u32 m0, s33, 34816
    s_add_u32 s35, s30, 20608
    buffer_load_dwordx4 v2, s[12:15], s35 offen lds
    s_add_u32 m0, s33, 35840
    s_add_u32 s35, s30, 30848
    buffer_load_dwordx4 v3, s[12:15], s35 offen lds
    s_add_u32 m0, s34, 49152
    s_add_u32 s35, s31, 245760
    buffer_load_dwordx4 v4, s[16:19], s35 offen lds
    s_add_u32 m0, s34, 50176
    s_add_u32 s35, s31, 261120
    buffer_load_dwordx4 v4, s[16:19], s35 offen lds
    s_add_u32 m0, s34, 51200
    s_add_u32 s35, s31, 276480
    buffer_load_dwordx4 v4, s[16:19], s35 offen lds
    s_add_u32 m0, s34, 52224
    s_add_u32 s35, s31, 291840
    buffer_load_dwordx4 v4, s[16:19], s35 offen lds
    s_add_u32 m0, s33, 65536
    s_add_u32 s35, s30, 256
    buffer_load_dwordx4 v2, s[12:15], s35 offen lds
    s_add_u32 m0, s33, 66560
    s_add_u32 s35, s30, 10496
    buffer_load_dwordx4 v3, s[12:15], s35 offen lds
    s_add_u32 m0, s33, 67584
    s_add_u32 s35, s30, 20736
    buffer_load_dwordx4 v2, s[12:15], s35 offen lds
    s_add_u32 m0, s33, 68608
    s_add_u32 s35, s30, 30976
    buffer_load_dwordx4 v3, s[12:15], s35 offen lds
    s_add_u32 m0, s34, 81920
    s_add_u32 s35, s31, 491520
    buffer_load_dwordx4 v4, s[16:19], s35 offen lds
    s_add_u32 m0, s34, 82944
    s_add_u32 s35, s31, 506880
    buffer_load_dwordx4 v4, s[16:19], s35 offen lds
    s_add_u32 m0, s34, 83968
    s_add_u32 s35, s31, 522240
    buffer_load_dwordx4 v4, s[16:19], s35 offen lds
    s_add_u32 m0, s34, 84992
    s_add_u32 s35, s31, 537600
    buffer_load_dwordx4 v4, s[16:19], s35 offen lds
    v_and_b32 v20, 31, v1
    v_lshrrev_b32 v21, 5, v1
    v_lshrrev_b32 v22, 1, v20
    v_and_b32 v22, 7, v22
    v_xor_b32 v22, v22, v21
    v_lshlrev_b32 v22, 4, v22
    v_lshlrev_b32 v23, 7, v20
    v_add_u32 v23, v23, v22
    s_lshr_b32 s36, s20, 1
    s_lshl_b32 s36, s36, 13
    v_add_u32 v23, s36, v23
    v_xor_b32 v8, 0, v23
    v_xor_b32 v9, 32, v23
    v_xor_b32 v10, 64, v23
    v_xor_b32 v11, 96, v23
    v_xor_b32 v12, 0, v23
    v_add_u32 v12, 0x10000, v12
    v_xor_b32 v13, 32, v23
    v_add_u32 v13, 0x10000, v13
    v_xor_b32 v14, 64, v23
    v_add_u32 v14, 0x10000, v14
    v_xor_b32 v15, 96, v23
    v_add_u32 v15, 0x10000, v15
    v_lshrrev_b32 v20, 4, v1
    v_and_b32 v21, 15, v1
    v_lshrrev_b32 v22, 2, v21
    v_and_b32 v23, 3, v21
    v_lshrrev_b32 v24, 1, v20
    v_lshlrev_b32 v24, 3, v24
    v_add_u32 v24, v24, v22
    v_lshlrev_b32 v24, 8, v24
    v_and_b32 v25, 1, v20
    v_lshlrev_b32 v25, 1, v25
    v_lshrrev_b32 v26, 1, v23
    v_add_u32 v25, v25, v26
    v_lshlrev_b32 v26, 2, v22
    v_xor_b32 v25, v25, v26
    v_lshlrev_b32 v25, 4, v25
    v_add_u32 v24, v24, v25
    v_and_b32 v25, 1, v23
    v_lshlrev_b32 v25, 3, v25
    v_add_u32 v24, v24, v25
    s_and_b32 s36, s20, 1
    s_lshl_b32 s36, s36, 7
    v_xor_b32 v16, s36, v24
    v_xor_b32 v17, s36, v24
    v_xor_b32 v17, 64, v17
    v_xor_b32 v18, s36, v24
    v_add_u32 v18, 0x10000, v18
    v_xor_b32 v19, s36, v24
    v_xor_b32 v19, 64, v19
    v_add_u32 v19, 0x10000, v19
    v_mov_b32 v64, 0
    v_mov_b32 v65, 0
    v_mov_b32 v66, 0
    v_mov_b32 v67, 0
    v_mov_b32 v68, 0
    v_mov_b32 v69, 0
    v_mov_b32 v70, 0
    v_mov_b32 v71, 0
    v_mov_b32 v72, 0
    v_mov_b32 v73, 0
    v_mov_b32 v74, 0
    v_mov_b32 v75, 0
    v_mov_b32 v76, 0
    v_mov_b32 v77, 0
    v_mov_b32 v78, 0
    v_mov_b32 v79, 0
    v_mov_b32 v80, 0
    v_mov_b32 v81, 0
    v_mov_b32 v82, 0
    v_mov_b32 v83, 0
    v_mov_b32 v84, 0
    v_mov_b32 v85, 0
    v_mov_b32 v86, 0
    v_mov_b32 v87, 0
    v_mov_b32 v88, 0
    v_mov_b32 v89, 0
    v_mov_b32 v90, 0
    v_mov_b32 v91, 0
    v_mov_b32 v92, 0
    v_mov_b32 v93, 0
    v_mov_b32 v94, 0
    v_mov_b32 v95, 0
    v_mov_b32 v96, 0
    v_mov_b32 v97, 0
    v_mov_b32 v98, 0
    v_mov_b32 v99, 0
    v_mov_b32 v100, 0
    v_mov_b32 v101, 0
    v_mov_b32 v102, 0
    v_mov_b32 v103, 0
    v_mov_b32 v104, 0
    v_mov_b32 v105, 0
    v_mov_b32 v106, 0
    v_mov_b32 v107, 0
    v_mov_b32 v108, 0
    v_mov_b32 v109, 0
    v_mov_b32 v110, 0
    v_mov_b32 v111, 0
    v_mov_b32 v112, 0
    v_mov_b32 v113, 0
    v_mov_b32 v114, 0
    v_mov_b32 v115, 0
    v_mov_b32 v116, 0
    v_mov_b32 v117, 0
    v_mov_b32 v118, 0
    v_mov_b32 v119, 0
    v_mov_b32 v120, 0
    v_mov_b32 v121, 0
    v_mov_b32 v122, 0
    v_mov_b32 v123, 0
    v_mov_b32 v124, 0
    v_mov_b32 v125, 0
    v_mov_b32 v126, 0
    v_mov_b32 v127, 0
    s_cmp_ge_u32 s25, 10
    s_cbranch_scc1 L_mha_qkv_kernel_v
    s_waitcnt vmcnt(16)
    s_barrier
    ds_read_b128 v[32:35], v8
    ds_read_b128 v[36:39], v8 offset:4096
    ds_read_b64_tr_b16 v[48:49], v16 offset:16384
    ds_read_b64_tr_b16 v[50:51], v16 offset:17408
    ds_read_b64_tr_b16 v[52:53], v17 offset:16384
    ds_read_b64_tr_b16 v[54:55], v17 offset:17408
    ds_read_b128 v[40:43], v9
    ds_read_b128 v[44:47], v9 offset:4096
    ds_read_b64_tr_b16 v[56:57], v16 offset:20480
    ds_read_b64_tr_b16 v[58:59], v16 offset:21504
    ds_read_b64_tr_b16 v[60:61], v17 offset:20480
    ds_read_b64_tr_b16 v[62:63], v17 offset:21504
    s_waitcnt lgkmcnt(6)
    v_mfma_f32_32x32x16_bf16 v[64:79], v[48:51], v[32:35], v[64:79]
    s_add_u32 m0, s33, 98304
    s_add_u32 s35, s30, 384
    buffer_load_dwordx4 v2, s[12:15], s35 offen lds
    v_mfma_f32_32x32x16_bf16 v[80:95], v[48:51], v[36:39], v[80:95]
    v_mfma_f32_32x32x16_bf16 v[96:111], v[52:55], v[32:35], v[96:111]
    s_add_u32 m0, s33, 99328
    s_add_u32 s35, s30, 10624
    buffer_load_dwordx4 v3, s[12:15], s35 offen lds
    v_mfma_f32_32x32x16_bf16 v[112:127], v[52:55], v[36:39], v[112:127]
    ds_read_b128 v[32:35], v10
    ds_read_b128 v[36:39], v10 offset:4096
    ds_read_b64_tr_b16 v[48:49], v16 offset:24576
    ds_read_b64_tr_b16 v[50:51], v16 offset:25600
    ds_read_b64_tr_b16 v[52:53], v17 offset:24576
    ds_read_b64_tr_b16 v[54:55], v17 offset:25600
    s_waitcnt lgkmcnt(6)
    v_mfma_f32_32x32x16_bf16 v[64:79], v[56:59], v[40:43], v[64:79]
    s_add_u32 m0, s33, 100352
    s_add_u32 s35, s30, 20864
    buffer_load_dwordx4 v2, s[12:15], s35 offen lds
    v_mfma_f32_32x32x16_bf16 v[80:95], v[56:59], v[44:47], v[80:95]
    v_mfma_f32_32x32x16_bf16 v[96:111], v[60:63], v[40:43], v[96:111]
    s_add_u32 m0, s33, 101376
    s_add_u32 s35, s30, 31104
    buffer_load_dwordx4 v3, s[12:15], s35 offen lds
    v_mfma_f32_32x32x16_bf16 v[112:127], v[60:63], v[44:47], v[112:127]
    ds_read_b128 v[40:43], v11
    ds_read_b128 v[44:47], v11 offset:4096
    ds_read_b64_tr_b16 v[56:57], v16 offset:28672
    ds_read_b64_tr_b16 v[58:59], v16 offset:29696
    ds_read_b64_tr_b16 v[60:61], v17 offset:28672
    ds_read_b64_tr_b16 v[62:63], v17 offset:29696
    s_waitcnt lgkmcnt(6)
    v_mfma_f32_32x32x16_bf16 v[64:79], v[48:51], v[32:35], v[64:79]
    s_add_u32 m0, s34, 114688
    s_add_u32 s35, s31, 737280
    buffer_load_dwordx4 v4, s[16:19], s35 offen lds
    v_mfma_f32_32x32x16_bf16 v[80:95], v[48:51], v[36:39], v[80:95]
    v_mfma_f32_32x32x16_bf16 v[96:111], v[52:55], v[32:35], v[96:111]
    s_add_u32 m0, s34, 115712
    s_add_u32 s35, s31, 752640
    buffer_load_dwordx4 v4, s[16:19], s35 offen lds
    v_mfma_f32_32x32x16_bf16 v[112:127], v[52:55], v[36:39], v[112:127]
    s_waitcnt lgkmcnt(0)
    v_mfma_f32_32x32x16_bf16 v[64:79], v[56:59], v[40:43], v[64:79]
    s_add_u32 m0, s34, 116736
    s_add_u32 s35, s31, 768000
    buffer_load_dwordx4 v4, s[16:19], s35 offen lds
    v_mfma_f32_32x32x16_bf16 v[80:95], v[56:59], v[44:47], v[80:95]
    v_mfma_f32_32x32x16_bf16 v[96:111], v[60:63], v[40:43], v[96:111]
    s_add_u32 m0, s34, 117760
    s_add_u32 s35, s31, 783360
    buffer_load_dwordx4 v4, s[16:19], s35 offen lds
    v_mfma_f32_32x32x16_bf16 v[112:127], v[60:63], v[44:47], v[112:127]
    s_waitcnt vmcnt(16)
    s_barrier
    ds_read_b128 v[32:35], v8 offset:32768
    ds_read_b128 v[36:39], v8 offset:36864
    ds_read_b64_tr_b16 v[48:49], v16 offset:49152
    ds_read_b64_tr_b16 v[50:51], v16 offset:50176
    ds_read_b64_tr_b16 v[52:53], v17 offset:49152
    ds_read_b64_tr_b16 v[54:55], v17 offset:50176
    ds_read_b128 v[40:43], v9 offset:32768
    ds_read_b128 v[44:47], v9 offset:36864
    ds_read_b64_tr_b16 v[56:57], v16 offset:53248
    ds_read_b64_tr_b16 v[58:59], v16 offset:54272
    ds_read_b64_tr_b16 v[60:61], v17 offset:53248
    ds_read_b64_tr_b16 v[62:63], v17 offset:54272
    s_waitcnt lgkmcnt(6)
    v_mfma_f32_32x32x16_bf16 v[64:79], v[48:51], v[32:35], v[64:79]
    s_add_u32 m0, s33, 0
    s_add_u32 s35, s30, 512
    buffer_load_dwordx4 v2, s[12:15], s35 offen lds
    v_mfma_f32_32x32x16_bf16 v[80:95], v[48:51], v[36:39], v[80:95]
    v_mfma_f32_32x32x16_bf16 v[96:111], v[52:55], v[32:35], v[96:111]
    s_add_u32 m0, s33, 1024
    s_add_u32 s35, s30, 10752
    buffer_load_dwordx4 v3, s[12:15], s35 offen lds
    v_mfma_f32_32x32x16_bf16 v[112:127], v[52:55], v[36:39], v[112:127]
    ds_read_b128 v[32:35], v10 offset:32768
    ds_read_b128 v[36:39], v10 offset:36864
    ds_read_b64_tr_b16 v[48:49], v16 offset:57344
    ds_read_b64_tr_b16 v[50:51], v16 offset:58368
    ds_read_b64_tr_b16 v[52:53], v17 offset:57344
    ds_read_b64_tr_b16 v[54:55], v17 offset:58368
    s_waitcnt lgkmcnt(6)
    v_mfma_f32_32x32x16_bf16 v[64:79], v[56:59], v[40:43], v[64:79]
    s_add_u32 m0, s33, 2048
    s_add_u32 s35, s30, 20992
    buffer_load_dwordx4 v2, s[12:15], s35 offen lds
    v_mfma_f32_32x32x16_bf16 v[80:95], v[56:59], v[44:47], v[80:95]
    v_mfma_f32_32x32x16_bf16 v[96:111], v[60:63], v[40:43], v[96:111]
    s_add_u32 m0, s33, 3072
    s_add_u32 s35, s30, 31232
    buffer_load_dwordx4 v3, s[12:15], s35 offen lds
    v_mfma_f32_32x32x16_bf16 v[112:127], v[60:63], v[44:47], v[112:127]
    ds_read_b128 v[40:43], v11 offset:32768
    ds_read_b128 v[44:47], v11 offset:36864
    ds_read_b64_tr_b16 v[56:57], v16 offset:61440
    ds_read_b64_tr_b16 v[58:59], v16 offset:62464
    ds_read_b64_tr_b16 v[60:61], v17 offset:61440
    ds_read_b64_tr_b16 v[62:63], v17 offset:62464
    s_waitcnt lgkmcnt(6)
    v_mfma_f32_32x32x16_bf16 v[64:79], v[48:51], v[32:35], v[64:79]
    s_add_u32 m0, s34, 16384
    s_add_u32 s35, s31, 983040
    buffer_load_dwordx4 v4, s[16:19], s35 offen lds
    v_mfma_f32_32x32x16_bf16 v[80:95], v[48:51], v[36:39], v[80:95]
    v_mfma_f32_32x32x16_bf16 v[96:111], v[52:55], v[32:35], v[96:111]
    s_add_u32 m0, s34, 17408
    s_add_u32 s35, s31, 998400
    buffer_load_dwordx4 v4, s[16:19], s35 offen lds
    v_mfma_f32_32x32x16_bf16 v[112:127], v[52:55], v[36:39], v[112:127]
    s_waitcnt lgkmcnt(0)
    v_mfma_f32_32x32x16_bf16 v[64:79], v[56:59], v[40:43], v[64:79]
    s_add_u32 m0, s34, 18432
    s_add_u32 s35, s31, 1013760
    buffer_load_dwordx4 v4, s[16:19], s35 offen lds
    v_mfma_f32_32x32x16_bf16 v[80:95], v[56:59], v[44:47], v[80:95]
    v_mfma_f32_32x32x16_bf16 v[96:111], v[60:63], v[40:43], v[96:111]
    s_add_u32 m0, s34, 19456
    s_add_u32 s35, s31, 1029120
    buffer_load_dwordx4 v4, s[16:19], s35 offen lds
    v_mfma_f32_32x32x16_bf16 v[112:127], v[60:63], v[44:47], v[112:127]
    s_waitcnt vmcnt(16)
    s_barrier
    ds_read_b128 v[32:35], v12
    ds_read_b128 v[36:39], v12 offset:4096
    ds_read_b64_tr_b16 v[48:49], v18 offset:16384
    ds_read_b64_tr_b16 v[50:51], v18 offset:17408
    ds_read_b64_tr_b16 v[52:53], v19 offset:16384
    ds_read_b64_tr_b16 v[54:55], v19 offset:17408
    ds_read_b128 v[40:43], v13
    ds_read_b128 v[44:47], v13 offset:4096
    ds_read_b64_tr_b16 v[56:57], v18 offset:20480
    ds_read_b64_tr_b16 v[58:59], v18 offset:21504
    ds_read_b64_tr_b16 v[60:61], v19 offset:20480
    ds_read_b64_tr_b16 v[62:63], v19 offset:21504
    s_waitcnt lgkmcnt(6)
    v_mfma_f32_32x32x16_bf16 v[64:79], v[48:51], v[32:35], v[64:79]
    s_add_u32 m0, s33, 32768
    s_add_u32 s35, s30, 640
    buffer_load_dwordx4 v2, s[12:15], s35 offen lds
    v_mfma_f32_32x32x16_bf16 v[80:95], v[48:51], v[36:39], v[80:95]
    v_mfma_f32_32x32x16_bf16 v[96:111], v[52:55], v[32:35], v[96:111]
    s_add_u32 m0, s33, 33792
    s_add_u32 s35, s30, 10880
    buffer_load_dwordx4 v3, s[12:15], s35 offen lds
    v_mfma_f32_32x32x16_bf16 v[112:127], v[52:55], v[36:39], v[112:127]
    ds_read_b128 v[32:35], v14
    ds_read_b128 v[36:39], v14 offset:4096
    ds_read_b64_tr_b16 v[48:49], v18 offset:24576
    ds_read_b64_tr_b16 v[50:51], v18 offset:25600
    ds_read_b64_tr_b16 v[52:53], v19 offset:24576
    ds_read_b64_tr_b16 v[54:55], v19 offset:25600
    s_waitcnt lgkmcnt(6)
    v_mfma_f32_32x32x16_bf16 v[64:79], v[56:59], v[40:43], v[64:79]
    s_add_u32 m0, s33, 34816
    s_add_u32 s35, s30, 21120
    buffer_load_dwordx4 v2, s[12:15], s35 offen lds
    v_mfma_f32_32x32x16_bf16 v[80:95], v[56:59], v[44:47], v[80:95]
    v_mfma_f32_32x32x16_bf16 v[96:111], v[60:63], v[40:43], v[96:111]
    s_add_u32 m0, s33, 35840
    s_add_u32 s35, s30, 31360
    buffer_load_dwordx4 v3, s[12:15], s35 offen lds
    v_mfma_f32_32x32x16_bf16 v[112:127], v[60:63], v[44:47], v[112:127]
    ds_read_b128 v[40:43], v15
    ds_read_b128 v[44:47], v15 offset:4096
    ds_read_b64_tr_b16 v[56:57], v18 offset:28672
    ds_read_b64_tr_b16 v[58:59], v18 offset:29696
    ds_read_b64_tr_b16 v[60:61], v19 offset:28672
    ds_read_b64_tr_b16 v[62:63], v19 offset:29696
    s_waitcnt lgkmcnt(6)
    v_mfma_f32_32x32x16_bf16 v[64:79], v[48:51], v[32:35], v[64:79]
    s_add_u32 m0, s34, 49152
    s_add_u32 s35, s31, 1228800
    buffer_load_dwordx4 v4, s[16:19], s35 offen lds
    v_mfma_f32_32x32x16_bf16 v[80:95], v[48:51], v[36:39], v[80:95]
    v_mfma_f32_32x32x16_bf16 v[96:111], v[52:55], v[32:35], v[96:111]
    s_add_u32 m0, s34, 50176
    s_add_u32 s35, s31, 1244160
    buffer_load_dwordx4 v4, s[16:19], s35 offen lds
    v_mfma_f32_32x32x16_bf16 v[112:127], v[52:55], v[36:39], v[112:127]
    s_waitcnt lgkmcnt(0)
    v_mfma_f32_32x32x16_bf16 v[64:79], v[56:59], v[40:43], v[64:79]
    s_add_u32 m0, s34, 51200
    s_add_u32 s35, s31, 1259520
    buffer_load_dwordx4 v4, s[16:19], s35 offen lds
    v_mfma_f32_32x32x16_bf16 v[80:95], v[56:59], v[44:47], v[80:95]
    v_mfma_f32_32x32x16_bf16 v[96:111], v[60:63], v[40:43], v[96:111]
    s_add_u32 m0, s34, 52224
    s_add_u32 s35, s31, 1274880
    buffer_load_dwordx4 v4, s[16:19], s35 offen lds
    v_mfma_f32_32x32x16_bf16 v[112:127], v[60:63], v[44:47], v[112:127]
    s_waitcnt vmcnt(16)
    s_barrier
    ds_read_b128 v[32:35], v12 offset:32768
    ds_read_b128 v[36:39], v12 offset:36864
    ds_read_b64_tr_b16 v[48:49], v18 offset:49152
    ds_read_b64_tr_b16 v[50:51], v18 offset:50176
    ds_read_b64_tr_b16 v[52:53], v19 offset:49152
    ds_read_b64_tr_b16 v[54:55], v19 offset:50176
    ds_read_b128 v[40:43], v13 offset:32768
    ds_read_b128 v[44:47], v13 offset:36864
    ds_read_b64_tr_b16 v[56:57], v18 offset:53248
    ds_read_b64_tr_b16 v[58:59], v18 offset:54272
    ds_read_b64_tr_b16 v[60:61], v19 offset:53248
    ds_read_b64_tr_b16 v[62:63], v19 offset:54272
    s_waitcnt lgkmcnt(6)
    v_mfma_f32_32x32x16_bf16 v[64:79], v[48:51], v[32:35], v[64:79]
    s_add_u32 m0, s33, 65536
    s_add_u32 s35, s30, 768
    buffer_load_dwordx4 v2, s[12:15], s35 offen lds
    v_mfma_f32_32x32x16_bf16 v[80:95], v[48:51], v[36:39], v[80:95]
    v_mfma_f32_32x32x16_bf16 v[96:111], v[52:55], v[32:35], v[96:111]
    s_add_u32 m0, s33, 66560
    s_add_u32 s35, s30, 11008
    buffer_load_dwordx4 v3, s[12:15], s35 offen lds
    v_mfma_f32_32x32x16_bf16 v[112:127], v[52:55], v[36:39], v[112:127]
    ds_read_b128 v[32:35], v14 offset:32768
    ds_read_b128 v[36:39], v14 offset:36864
    ds_read_b64_tr_b16 v[48:49], v18 offset:57344
    ds_read_b64_tr_b16 v[50:51], v18 offset:58368
    ds_read_b64_tr_b16 v[52:53], v19 offset:57344
    ds_read_b64_tr_b16 v[54:55], v19 offset:58368
    s_waitcnt lgkmcnt(6)
    v_mfma_f32_32x32x16_bf16 v[64:79], v[56:59], v[40:43], v[64:79]
    s_add_u32 m0, s33, 67584
    s_add_u32 s35, s30, 21248
    buffer_load_dwordx4 v2, s[12:15], s35 offen lds
    v_mfma_f32_32x32x16_bf16 v[80:95], v[56:59], v[44:47], v[80:95]
    v_mfma_f32_32x32x16_bf16 v[96:111], v[60:63], v[40:43], v[96:111]
    s_add_u32 m0, s33, 68608
    s_add_u32 s35, s30, 31488
    buffer_load_dwordx4 v3, s[12:15], s35 offen lds
    v_mfma_f32_32x32x16_bf16 v[112:127], v[60:63], v[44:47], v[112:127]
    ds_read_b128 v[40:43], v15 offset:32768
    ds_read_b128 v[44:47], v15 offset:36864
    ds_read_b64_tr_b16 v[56:57], v18 offset:61440
    ds_read_b64_tr_b16 v[58:59], v18 offset:62464
    ds_read_b64_tr_b16 v[60:61], v19 offset:61440
    ds_read_b64_tr_b16 v[62:63], v19 offset:62464
    s_waitcnt lgkmcnt(6)
    v_mfma_f32_32x32x16_bf16 v[64:79], v[48:51], v[32:35], v[64:79]
    s_add_u32 m0, s34, 81920
    s_add_u32 s35, s31, 1474560
    buffer_load_dwordx4 v4, s[16:19], s35 offen lds
    v_mfma_f32_32x32x16_bf16 v[80:95], v[48:51], v[36:39], v[80:95]
    v_mfma_f32_32x32x16_bf16 v[96:111], v[52:55], v[32:35], v[96:111]
    s_add_u32 m0, s34, 82944
    s_add_u32 s35, s31, 1489920
    buffer_load_dwordx4 v4, s[16:19], s35 offen lds
    v_mfma_f32_32x32x16_bf16 v[112:127], v[52:55], v[36:39], v[112:127]
    s_waitcnt lgkmcnt(0)
    v_mfma_f32_32x32x16_bf16 v[64:79], v[56:59], v[40:43], v[64:79]
    s_add_u32 m0, s34, 83968
    s_add_u32 s35, s31, 1505280
    buffer_load_dwordx4 v4, s[16:19], s35 offen lds
    v_mfma_f32_32x32x16_bf16 v[80:95], v[56:59], v[44:47], v[80:95]
    v_mfma_f32_32x32x16_bf16 v[96:111], v[60:63], v[40:43], v[96:111]
    s_add_u32 m0, s34, 84992
    s_add_u32 s35, s31, 1520640
    buffer_load_dwordx4 v4, s[16:19], s35 offen lds
    v_mfma_f32_32x32x16_bf16 v[112:127], v[60:63], v[44:47], v[112:127]
    s_waitcnt vmcnt(16)
    s_barrier
    ds_read_b128 v[32:35], v8
    ds_read_b128 v[36:39], v8 offset:4096
    ds_read_b64_tr_b16 v[48:49], v16 offset:16384
    ds_read_b64_tr_b16 v[50:51], v16 offset:17408
    ds_read_b64_tr_b16 v[52:53], v17 offset:16384
    ds_read_b64_tr_b16 v[54:55], v17 offset:17408
    ds_read_b128 v[40:43], v9
    ds_read_b128 v[44:47], v9 offset:4096
    ds_read_b64_tr_b16 v[56:57], v16 offset:20480
    ds_read_b64_tr_b16 v[58:59], v16 offset:21504
    ds_read_b64_tr_b16 v[60:61], v17 offset:20480
    ds_read_b64_tr_b16 v[62:63], v17 offset:21504
    s_waitcnt lgkmcnt(6)
    v_mfma_f32_32x32x16_bf16 v[64:79], v[48:51], v[32:35], v[64:79]
    s_add_u32 m0, s33, 98304
    s_add_u32 s35, s30, 896
    buffer_load_dwordx4 v2, s[12:15], s35 offen lds
    v_mfma_f32_32x32x16_bf16 v[80:95], v[48:51], v[36:39], v[80:95]
    v_mfma_f32_32x32x16_bf16 v[96:111], v[52:55], v[32:35], v[96:111]
    s_add_u32 m0, s33, 99328
    s_add_u32 s35, s30, 11136
    buffer_load_dwordx4 v3, s[12:15], s35 offen lds
    v_mfma_f32_32x32x16_bf16 v[112:127], v[52:55], v[36:39], v[112:127]
    ds_read_b128 v[32:35], v10
    ds_read_b128 v[36:39], v10 offset:4096
    ds_read_b64_tr_b16 v[48:49], v16 offset:24576
    ds_read_b64_tr_b16 v[50:51], v16 offset:25600
    ds_read_b64_tr_b16 v[52:53], v17 offset:24576
    ds_read_b64_tr_b16 v[54:55], v17 offset:25600
    s_waitcnt lgkmcnt(6)
    v_mfma_f32_32x32x16_bf16 v[64:79], v[56:59], v[40:43], v[64:79]
    s_add_u32 m0, s33, 100352
    s_add_u32 s35, s30, 21376
    buffer_load_dwordx4 v2, s[12:15], s35 offen lds
    v_mfma_f32_32x32x16_bf16 v[80:95], v[56:59], v[44:47], v[80:95]
    v_mfma_f32_32x32x16_bf16 v[96:111], v[60:63], v[40:43], v[96:111]
    s_add_u32 m0, s33, 101376
    s_add_u32 s35, s30, 31616
    buffer_load_dwordx4 v3, s[12:15], s35 offen lds
    v_mfma_f32_32x32x16_bf16 v[112:127], v[60:63], v[44:47], v[112:127]
    ds_read_b128 v[40:43], v11
    ds_read_b128 v[44:47], v11 offset:4096
    ds_read_b64_tr_b16 v[56:57], v16 offset:28672
    ds_read_b64_tr_b16 v[58:59], v16 offset:29696
    ds_read_b64_tr_b16 v[60:61], v17 offset:28672
    ds_read_b64_tr_b16 v[62:63], v17 offset:29696
    s_waitcnt lgkmcnt(6)
    v_mfma_f32_32x32x16_bf16 v[64:79], v[48:51], v[32:35], v[64:79]
    s_add_u32 m0, s34, 114688
    s_add_u32 s35, s31, 1720320
    buffer_load_dwordx4 v4, s[16:19], s35 offen lds
    v_mfma_f32_32x32x16_bf16 v[80:95], v[48:51], v[36:39], v[80:95]
    v_mfma_f32_32x32x16_bf16 v[96:111], v[52:55], v[32:35], v[96:111]
    s_add_u32 m0, s34, 115712
    s_add_u32 s35, s31, 1735680
    buffer_load_dwordx4 v4, s[16:19], s35 offen lds
    v_mfma_f32_32x32x16_bf16 v[112:127], v[52:55], v[36:39], v[112:127]
    s_waitcnt lgkmcnt(0)
    v_mfma_f32_32x32x16_bf16 v[64:79], v[56:59], v[40:43], v[64:79]
    s_add_u32 m0, s34, 116736
    s_add_u32 s35, s31, 1751040
    buffer_load_dwordx4 v4, s[16:19], s35 offen lds
    v_mfma_f32_32x32x16_bf16 v[80:95], v[56:59], v[44:47], v[80:95]
    v_mfma_f32_32x32x16_bf16 v[96:111], v[60:63], v[40:43], v[96:111]
    s_add_u32 m0, s34, 117760
    s_add_u32 s35, s31, 1766400
    buffer_load_dwordx4 v4, s[16:19], s35 offen lds
    v_mfma_f32_32x32x16_bf16 v[112:127], v[60:63], v[44:47], v[112:127]
    s_waitcnt vmcnt(16)
    s_barrier
    ds_read_b128 v[32:35], v8 offset:32768
    ds_read_b128 v[36:39], v8 offset:36864
    ds_read_b64_tr_b16 v[48:49], v16 offset:49152
    ds_read_b64_tr_b16 v[50:51], v16 offset:50176
    ds_read_b64_tr_b16 v[52:53], v17 offset:49152
    ds_read_b64_tr_b16 v[54:55], v17 offset:50176
    ds_read_b128 v[40:43], v9 offset:32768
    ds_read_b128 v[44:47], v9 offset:36864
    ds_read_b64_tr_b16 v[56:57], v16 offset:53248
    ds_read_b64_tr_b16 v[58:59], v16 offset:54272
    ds_read_b64_tr_b16 v[60:61], v17 offset:53248
    ds_read_b64_tr_b16 v[62:63], v17 offset:54272
    s_waitcnt lgkmcnt(6)
    v_mfma_f32_32x32x16_bf16 v[64:79], v[48:51], v[32:35], v[64:79]
    s_add_u32 m0, s33, 0
    s_add_u32 s35, s30, 1024
    buffer_load_dwordx4 v2, s[12:15], s35 offen lds
    v_mfma_f32_32x32x16_bf16 v[80:95], v[48:51], v[36:39], v[80:95]
    v_mfma_f32_32x32x16_bf16 v[96:111], v[52:55], v[32:35], v[96:111]
    s_add_u32 m0, s33, 1024
    s_add_u32 s35, s30, 11264
    buffer_load_dwordx4 v3, s[12:15], s35 offen lds
    v_mfma_f32_32x32x16_bf16 v[112:127], v[52:55], v[36:39], v[112:127]
    ds_read_b128 v[32:35], v10 offset:32768
    ds_read_b128 v[36:39], v10 offset:36864
    ds_read_b64_tr_b16 v[48:49], v16 offset:57344
    ds_read_b64_tr_b16 v[50:51], v16 offset:58368
    ds_read_b64_tr_b16 v[52:53], v17 offset:57344
    ds_read_b64_tr_b16 v[54:55], v17 offset:58368
    s_waitcnt lgkmcnt(6)
    v_mfma_f32_32x32x16_bf16 v[64:79], v[56:59], v[40:43], v[64:79]
    s_add_u32 m0, s33, 2048
    s_add_u32 s35, s30, 21504
    buffer_load_dwordx4 v2, s[12:15], s35 offen lds
    v_mfma_f32_32x32x16_bf16 v[80:95], v[56:59], v[44:47], v[80:95]
    v_mfma_f32_32x32x16_bf16 v[96:111], v[60:63], v[40:43], v[96:111]
    s_add_u32 m0, s33, 3072
    s_add_u32 s35, s30, 31744
    buffer_load_dwordx4 v3, s[12:15], s35 offen lds
    v_mfma_f32_32x32x16_bf16 v[112:127], v[60:63], v[44:47], v[112:127]
    ds_read_b128 v[40:43], v11 offset:32768
    ds_read_b128 v[44:47], v11 offset:36864
    ds_read_b64_tr_b16 v[56:57], v16 offset:61440
    ds_read_b64_tr_b16 v[58:59], v16 offset:62464
    ds_read_b64_tr_b16 v[60:61], v17 offset:61440
    ds_read_b64_tr_b16 v[62:63], v17 offset:62464
    s_waitcnt lgkmcnt(6)
    v_mfma_f32_32x32x16_bf16 v[64:79], v[48:51], v[32:35], v[64:79]
    s_add_u32 m0, s34, 16384
    s_add_u32 s35, s31, 1966080
    buffer_load_dwordx4 v4, s[16:19], s35 offen lds
    v_mfma_f32_32x32x16_bf16 v[80:95], v[48:51], v[36:39], v[80:95]
    v_mfma_f32_32x32x16_bf16 v[96:111], v[52:55], v[32:35], v[96:111]
    s_add_u32 m0, s34, 17408
    s_add_u32 s35, s31, 1981440
    buffer_load_dwordx4 v4, s[16:19], s35 offen lds
    v_mfma_f32_32x32x16_bf16 v[112:127], v[52:55], v[36:39], v[112:127]
    s_waitcnt lgkmcnt(0)
    v_mfma_f32_32x32x16_bf16 v[64:79], v[56:59], v[40:43], v[64:79]
    s_add_u32 m0, s34, 18432
    s_add_u32 s35, s31, 1996800
    buffer_load_dwordx4 v4, s[16:19], s35 offen lds
    v_mfma_f32_32x32x16_bf16 v[80:95], v[56:59], v[44:47], v[80:95]
    v_mfma_f32_32x32x16_bf16 v[96:111], v[60:63], v[40:43], v[96:111]
    s_add_u32 m0, s34, 19456
    s_add_u32 s35, s31, 2012160
    buffer_load_dwordx4 v4, s[16:19], s35 offen lds
    v_mfma_f32_32x32x16_bf16 v[112:127], v[60:63], v[44:47], v[112:127]
    s_waitcnt vmcnt(16)
    s_barrier
    ds_read_b128 v[32:35], v12
    ds_read_b128 v[36:39], v12 offset:4096
    ds_read_b64_tr_b16 v[48:49], v18 offset:16384
    ds_read_b64_tr_b16 v[50:51], v18 offset:17408
    ds_read_b64_tr_b16 v[52:53], v19 offset:16384
    ds_read_b64_tr_b16 v[54:55], v19 offset:17408
    ds_read_b128 v[40:43], v13
    ds_read_b128 v[44:47], v13 offset:4096
    ds_read_b64_tr_b16 v[56:57], v18 offset:20480
    ds_read_b64_tr_b16 v[58:59], v18 offset:21504
    ds_read_b64_tr_b16 v[60:61], v19 offset:20480
    ds_read_b64_tr_b16 v[62:63], v19 offset:21504
    s_waitcnt lgkmcnt(6)
    v_mfma_f32_32x32x16_bf16 v[64:79], v[48:51], v[32:35], v[64:79]
    s_add_u32 m0, s33, 32768
    s_add_u32 s35, s30, 1152
    buffer_load_dwordx4 v2, s[12:15], s35 offen lds
    v_mfma_f32_32x32x16_bf16 v[80:95], v[48:51], v[36:39], v[80:95]
    v_mfma_f32_32x32x16_bf16 v[96:111], v[52:55], v[32:35], v[96:111]
    s_add_u32 m0, s33, 33792
    s_add_u32 s35, s30, 11392
    buffer_load_dwordx4 v3, s[12:15], s35 offen lds
    v_mfma_f32_32x32x16_bf16 v[112:127], v[52:55], v[36:39], v[112:127]
    ds_read_b128 v[32:35], v14
    ds_read_b128 v[36:39], v14 offset:4096
    ds_read_b64_tr_b16 v[48:49], v18 offset:24576
    ds_read_b64_tr_b16 v[50:51], v18 offset:25600
    ds_read_b64_tr_b16 v[52:53], v19 offset:24576
    ds_read_b64_tr_b16 v[54:55], v19 offset:25600
    s_waitcnt lgkmcnt(6)
    v_mfma_f32_32x32x16_bf16 v[64:79], v[56:59], v[40:43], v[64:79]
    s_add_u32 m0, s33, 34816
    s_add_u32 s35, s30, 21632
    buffer_load_dwordx4 v2, s[12:15], s35 offen lds
    v_mfma_f32_32x32x16_bf16 v[80:95], v[56:59], v[44:47], v[80:95]
    v_mfma_f32_32x32x16_bf16 v[96:111], v[60:63], v[40:43], v[96:111]
    s_add_u32 m0, s33, 35840
    s_add_u32 s35, s30, 31872
    buffer_load_dwordx4 v3, s[12:15], s35 offen lds
    v_mfma_f32_32x32x16_bf16 v[112:127], v[60:63], v[44:47], v[112:127]
    ds_read_b128 v[40:43], v15
    ds_read_b128 v[44:47], v15 offset:4096
    ds_read_b64_tr_b16 v[56:57], v18 offset:28672
    ds_read_b64_tr_b16 v[58:59], v18 offset:29696
    ds_read_b64_tr_b16 v[60:61], v19 offset:28672
    ds_read_b64_tr_b16 v[62:63], v19 offset:29696
    s_waitcnt lgkmcnt(6)
    v_mfma_f32_32x32x16_bf16 v[64:79], v[48:51], v[32:35], v[64:79]
    s_add_u32 m0, s34, 49152
    s_add_u32 s35, s31, 2211840
    buffer_load_dwordx4 v4, s[16:19], s35 offen lds
    v_mfma_f32_32x32x16_bf16 v[80:95], v[48:51], v[36:39], v[80:95]
    v_mfma_f32_32x32x16_bf16 v[96:111], v[52:55], v[32:35], v[96:111]
    s_add_u32 m0, s34, 50176
    s_add_u32 s35, s31, 2227200
    buffer_load_dwordx4 v4, s[16:19], s35 offen lds
    v_mfma_f32_32x32x16_bf16 v[112:127], v[52:55], v[36:39], v[112:127]
    s_waitcnt lgkmcnt(0)
    v_mfma_f32_32x32x16_bf16 v[64:79], v[56:59], v[40:43], v[64:79]
    s_add_u32 m0, s34, 51200
    s_add_u32 s35, s31, 2242560
    buffer_load_dwordx4 v4, s[16:19], s35 offen lds
    v_mfma_f32_32x32x16_bf16 v[80:95], v[56:59], v[44:47], v[80:95]
    v_mfma_f32_32x32x16_bf16 v[96:111], v[60:63], v[40:43], v[96:111]
    s_add_u32 m0, s34, 52224
    s_add_u32 s35, s31, 2257920
    buffer_load_dwordx4 v4, s[16:19], s35 offen lds
    v_mfma_f32_32x32x16_bf16 v[112:127], v[60:63], v[44:47], v[112:127]
    s_waitcnt vmcnt(16)
    s_barrier
    ds_read_b128 v[32:35], v12 offset:32768
    ds_read_b128 v[36:39], v12 offset:36864
    ds_read_b64_tr_b16 v[48:49], v18 offset:49152
    ds_read_b64_tr_b16 v[50:51], v18 offset:50176
    ds_read_b64_tr_b16 v[52:53], v19 offset:49152
    ds_read_b64_tr_b16 v[54:55], v19 offset:50176
    ds_read_b128 v[40:43], v13 offset:32768
    ds_read_b128 v[44:47], v13 offset:36864
    ds_read_b64_tr_b16 v[56:57], v18 offset:53248
    ds_read_b64_tr_b16 v[58:59], v18 offset:54272
    ds_read_b64_tr_b16 v[60:61], v19 offset:53248
    ds_read_b64_tr_b16 v[62:63], v19 offset:54272
    s_waitcnt lgkmcnt(6)
    v_mfma_f32_32x32x16_bf16 v[64:79], v[48:51], v[32:35], v[64:79]
    v_mfma_f32_32x32x16_bf16 v[80:95], v[48:51], v[36:39], v[80:95]
    v_mfma_f32_32x32x16_bf16 v[96:111], v[52:55], v[32:35], v[96:111]
    v_mfma_f32_32x32x16_bf16 v[112:127], v[52:55], v[36:39], v[112:127]
    ds_read_b128 v[32:35], v14 offset:32768
    ds_read_b128 v[36:39], v14 offset:36864
    ds_read_b64_tr_b16 v[48:49], v18 offset:57344
    ds_read_b64_tr_b16 v[50:51], v18 offset:58368
    ds_read_b64_tr_b16 v[52:53], v19 offset:57344
    ds_read_b64_tr_b16 v[54:55], v19 offset:58368
    s_waitcnt lgkmcnt(6)
    v_mfma_f32_32x32x16_bf16 v[64:79], v[56:59], v[40:43], v[64:79]
    v_mfma_f32_32x32x16_bf16 v[80:95], v[56:59], v[44:47], v[80:95]
    v_mfma_f32_32x32x16_bf16 v[96:111], v[60:63], v[40:43], v[96:111]
    v_mfma_f32_32x32x16_bf16 v[112:127], v[60:63], v[44:47], v[112:127]
    ds_read_b128 v[40:43], v15 offset:32768
    ds_read_b128 v[44:47], v15 offset:36864
    ds_read_b64_tr_b16 v[56:57], v18 offset:61440
    ds_read_b64_tr_b16 v[58:59], v18 offset:62464
    ds_read_b64_tr_b16 v[60:61], v19 offset:61440
    ds_read_b64_tr_b16 v[62:63], v19 offset:62464
    s_waitcnt lgkmcnt(6)
    v_mfma_f32_32x32x16_bf16 v[64:79], v[48:51], v[32:35], v[64:79]
    v_mfma_f32_32x32x16_bf16 v[80:95], v[48:51], v[36:39], v[80:95]
    v_mfma_f32_32x32x16_bf16 v[96:111], v[52:55], v[32:35], v[96:111]
    v_mfma_f32_32x32x16_bf16 v[112:127], v[52:55], v[36:39], v[112:127]
    s_waitcnt lgkmcnt(0)
    v_mfma_f32_32x32x16_bf16 v[64:79], v[56:59], v[40:43], v[64:79]
    v_mfma_f32_32x32x16_bf16 v[80:95], v[56:59], v[44:47], v[80:95]
    v_mfma_f32_32x32x16_bf16 v[96:111], v[60:63], v[40:43], v[96:111]
    v_mfma_f32_32x32x16_bf16 v[112:127], v[60:63], v[44:47], v[112:127]
    s_waitcnt vmcnt(8)
    s_barrier
    ds_read_b128 v[32:35], v8
    ds_read_b128 v[36:39], v8 offset:4096
    ds_read_b64_tr_b16 v[48:49], v16 offset:16384
    ds_read_b64_tr_b16 v[50:51], v16 offset:17408
    ds_read_b64_tr_b16 v[52:53], v17 offset:16384
    ds_read_b64_tr_b16 v[54:55], v17 offset:17408
    ds_read_b128 v[40:43], v9
    ds_read_b128 v[44:47], v9 offset:4096
    ds_read_b64_tr_b16 v[56:57], v16 offset:20480
    ds_read_b64_tr_b16 v[58:59], v16 offset:21504
    ds_read_b64_tr_b16 v[60:61], v17 offset:20480
    ds_read_b64_tr_b16 v[62:63], v17 offset:21504
    s_waitcnt lgkmcnt(6)
    v_mfma_f32_32x32x16_bf16 v[64:79], v[48:51], v[32:35], v[64:79]
    v_mfma_f32_32x32x16_bf16 v[80:95], v[48:51], v[36:39], v[80:95]
    v_mfma_f32_32x32x16_bf16 v[96:111], v[52:55], v[32:35], v[96:111]
    v_mfma_f32_32x32x16_bf16 v[112:127], v[52:55], v[36:39], v[112:127]
    ds_read_b128 v[32:35], v10
    ds_read_b128 v[36:39], v10 offset:4096
    ds_read_b64_tr_b16 v[48:49], v16 offset:24576
    ds_read_b64_tr_b16 v[50:51], v16 offset:25600
    ds_read_b64_tr_b16 v[52:53], v17 offset:24576
    ds_read_b64_tr_b16 v[54:55], v17 offset:25600
    s_waitcnt lgkmcnt(6)
    v_mfma_f32_32x32x16_bf16 v[64:79], v[56:59], v[40:43], v[64:79]
    v_mfma_f32_32x32x16_bf16 v[80:95], v[56:59], v[44:47], v[80:95]
    v_mfma_f32_32x32x16_bf16 v[96:111], v[60:63], v[40:43], v[96:111]
    v_mfma_f32_32x32x16_bf16 v[112:127], v[60:63], v[44:47], v[112:127]
    ds_read_b128 v[40:43], v11
    ds_read_b128 v[44:47], v11 offset:4096
    ds_read_b64_tr_b16 v[56:57], v16 offset:28672
    ds_read_b64_tr_b16 v[58:59], v16 offset:29696
    ds_read_b64_tr_b16 v[60:61], v17 offset:28672
    ds_read_b64_tr_b16 v[62:63], v17 offset:29696
    s_waitcnt lgkmcnt(6)
    v_mfma_f32_32x32x16_bf16 v[64:79], v[48:51], v[32:35], v[64:79]
    v_mfma_f32_32x32x16_bf16 v[80:95], v[48:51], v[36:39], v[80:95]
    v_mfma_f32_32x32x16_bf16 v[96:111], v[52:55], v[32:35], v[96:111]
    v_mfma_f32_32x32x16_bf16 v[112:127], v[52:55], v[36:39], v[112:127]
    s_waitcnt lgkmcnt(0)
    v_mfma_f32_32x32x16_bf16 v[64:79], v[56:59], v[40:43], v[64:79]
    v_mfma_f32_32x32x16_bf16 v[80:95], v[56:59], v[44:47], v[80:95]
    v_mfma_f32_32x32x16_bf16 v[96:111], v[60:63], v[40:43], v[96:111]
    v_mfma_f32_32x32x16_bf16 v[112:127], v[60:63], v[44:47], v[112:127]
    s_waitcnt vmcnt(0)
    s_barrier
    ds_read_b128 v[32:35], v8 offset:32768
    ds_read_b128 v[36:39], v8 offset:36864
    ds_read_b64_tr_b16 v[48:49], v16 offset:49152
    ds_read_b64_tr_b16 v[50:51], v16 offset:50176
    ds_read_b64_tr_b16 v[52:53], v17 offset:49152
    ds_read_b64_tr_b16 v[54:55], v17 offset:50176
    ds_read_b128 v[40:43], v9 offset:32768
    ds_read_b128 v[44:47], v9 offset:36864
    ds_read_b64_tr_b16 v[56:57], v16 offset:53248
    ds_read_b64_tr_b16 v[58:59], v16 offset:54272
    ds_read_b64_tr_b16 v[60:61], v17 offset:53248
    ds_read_b64_tr_b16 v[62:63], v17 offset:54272
    s_waitcnt lgkmcnt(6)
    v_mfma_f32_32x32x16_bf16 v[64:79], v[48:51], v[32:35], v[64:79]
    v_mfma_f32_32x32x16_bf16 v[80:95], v[48:51], v[36:39], v[80:95]
    v_mfma_f32_32x32x16_bf16 v[96:111], v[52:55], v[32:35], v[96:111]
    v_mfma_f32_32x32x16_bf16 v[112:127], v[52:55], v[36:39], v[112:127]
    ds_read_b128 v[32:35], v10 offset:32768
    ds_read_b128 v[36:39], v10 offset:36864
    ds_read_b64_tr_b16 v[48:49], v16 offset:57344
    ds_read_b64_tr_b16 v[50:51], v16 offset:58368
    ds_read_b64_tr_b16 v[52:53], v17 offset:57344
    ds_read_b64_tr_b16 v[54:55], v17 offset:58368
    s_waitcnt lgkmcnt(6)
    v_mfma_f32_32x32x16_bf16 v[64:79], v[56:59], v[40:43], v[64:79]
    v_mfma_f32_32x32x16_bf16 v[80:95], v[56:59], v[44:47], v[80:95]
    v_mfma_f32_32x32x16_bf16 v[96:111], v[60:63], v[40:43], v[96:111]
    v_mfma_f32_32x32x16_bf16 v[112:127], v[60:63], v[44:47], v[112:127]
    ds_read_b128 v[40:43], v11 offset:32768
    ds_read_b128 v[44:47], v11 offset:36864
    ds_read_b64_tr_b16 v[56:57], v16 offset:61440
    ds_read_b64_tr_b16 v[58:59], v16 offset:62464
    ds_read_b64_tr_b16 v[60:61], v17 offset:61440
    ds_read_b64_tr_b16 v[62:63], v17 offset:62464
    s_waitcnt lgkmcnt(6)
    v_mfma_f32_32x32x16_bf16 v[64:79], v[48:51], v[32:35], v[64:79]
    v_mfma_f32_32x32x16_bf16 v[80:95], v[48:51], v[36:39], v[80:95]
    v_mfma_f32_32x32x16_bf16 v[96:111], v[52:55], v[32:35], v[96:111]
    v_mfma_f32_32x32x16_bf16 v[112:127], v[52:55], v[36:39], v[112:127]
    s_waitcnt lgkmcnt(0)
    v_mfma_f32_32x32x16_bf16 v[64:79], v[56:59], v[40:43], v[64:79]
    v_mfma_f32_32x32x16_bf16 v[80:95], v[56:59], v[44:47], v[80:95]
    v_mfma_f32_32x32x16_bf16 v[96:111], v[60:63], v[40:43], v[96:111]
    v_mfma_f32_32x32x16_bf16 v[112:127], v[60:63], v[44:47], v[112:127]
    s_nop 15
    s_nop 15
    s_barrier
    s_lshr_b32 s36, s20, 1
    s_lshl_b32 s36, s36, 6
    v_and_b32 v20, 31, v1
    v_add_u32 v20, s36, v20
    v_lshrrev_b32 v21, 5, v1
    v_lshlrev_b32 v21, 2, v21
    s_and_b32 s36, s20, 1
    s_lshl_b32 s36, s36, 6
    s_cmp_ge_u32 s25, 5
    s_cbranch_scc1 L_mha_qkv_kernel_kpart
    s_lshl_b32 s51, s25, 7
    s_sub_u32 s51, s51, 0
    s_mul_i32 s50, s51, 52429
    s_lshr_b32 s50, s50, 20
    s_mul_i32 s52, s50, 20
    s_sub_u32 s51, s51, s52
    s_add_u32 s36, s36, s51
    v_add_u32 v22, 0, v20
    v_mul_u32_u24 v22, 40, v22
    v_add_u32 v23, 32, v20
    v_mul_u32_u24 v23, 40, v23
    s_add_u32 s37, s36, 0
    v_add_u32 v24, s37, v21
    v_mul_u32_u24 v25, 52429, v24
    v_lshrrev_b32 v25, 20, v25
    v_mul_u32_u24 v27, 20, v25
    v_sub_u32 v26, v24, v27
    v_mul_u32_u24 v25, 5120, v25
    v_lshl_add_u32 v25, v26, 1, v25
    v_mul_f32 v64, 0x3ea52b5c, v64
    v_mul_f32 v65, 0x3ea52b5c, v65
    v_mul_f32 v66, 0x3ea52b5c, v66
    v_mul_f32 v67, 0x3ea52b5c, v67
    v_cvt_pk_bf16_f32 v64, v64, v65
    v_cvt_pk_bf16_f32 v65, v66, v67
    v_add_u32 v27, v25, v22
    ds_write_b64 v27, v[64:65]
    v_mul_f32 v80, 0x3ea52b5c, v80
    v_mul_f32 v81, 0x3ea52b5c, v81
    v_mul_f32 v82, 0x3ea52b5c, v82
    v_mul_f32 v83, 0x3ea52b5c, v83
    v_cvt_pk_bf16_f32 v80, v80, v81
    v_cvt_pk_bf16_f32 v81, v82, v83
    v_add_u32 v27, v25, v23
    ds_write_b64 v27, v[80:81]
    s_add_u32 s37, s36, 8
    v_add_u32 v24, s37, v21
    v_mul_u32_u24 v25, 52429, v24
    v_lshrrev_b32 v25, 20, v25
    v_mul_u32_u24 v27, 20, v25
    v_sub_u32 v26, v24, v27
    v_mul_u32_u24 v25, 5120, v25
    v_lshl_add_u32 v25, v26, 1, v25
    v_mul_f32 v68, 0x3ea52b5c, v68
    v_mul_f32 v69, 0x3ea52b5c, v69
    v_mul_f32 v70, 0x3ea52b5c, v70
    v_mul_f32 v71, 0x3ea52b5c, v71
    v_cvt_pk_bf16_f32 v68, v68, v69
    v_cvt_pk_bf16_f32 v69, v70, v71
    v_add_u32 v27, v25, v22
    ds_write_b64 v27, v[68:69]
    v_mul_f32 v84, 0x3ea52b5c, v84
    v_mul_f32 v85, 0x3ea52b5c, v85
    v_mul_f32 v86, 0x3ea52b5c, v86
    v_mul_f32 v87, 0x3ea52b5c, v87
    v_cvt_pk_bf16_f32 v84, v84, v85
    v_cvt_pk_bf16_f32 v85, v86, v87
    v_add_u32 v27, v25, v23
    ds_write_b64 v27, v[84:85]
    s_add_u32 s37, s36, 16
    v_add_u32 v24, s37, v21
    v_mul_u32_u24 v25, 52429, v24
    v_lshrrev_b32 v25, 20, v25
    v_mul_u32_u24 v27, 20, v25
    v_sub_u32 v26, v24, v27
    v_mul_u32_u24 v25, 5120, v25
    v_lshl_add_u32 v25, v26, 1, v25
    v_mul_f32 v72, 0x3ea52b5c, v72
    v_mul_f32 v73, 0x3ea52b5c, v73
    v_mul_f32 v74, 0x3ea52b5c, v74
    v_mul_f32 v75, 0x3ea52b5c, v75
    v_cvt_pk_bf16_f32 v72, v72, v73
    v_cvt_pk_bf16_f32 v73, v74, v75
    v_add_u32 v27, v25, v22
    ds_write_b64 v27, v[72:73]
    v_mul_f32 v88, 0x3ea52b5c, v88
    v_mul_f32 v89, 0x3ea52b5c, v89
    v_mul_f32 v90, 0x3ea52b5c, v90
    v_mul_f32 v91, 0x3ea52b5c, v91
    v_cvt_pk_bf16_f32 v88, v88, v89
    v_cvt_pk_bf16_f32 v89, v90, v91
    v_add_u32 v27, v25, v23
    ds_write_b64 v27, v[88:89]
    s_add_u32 s37, s36, 24
    v_add_u32 v24, s37, v21
    v_mul_u32_u24 v25, 52429, v24
    v_lshrrev_b32 v25, 20, v25
    v_mul_u32_u24 v27, 20, v25
    v_sub_u32 v26, v24, v27
    v_mul_u32_u24 v25, 5120, v25
    v_lshl_add_u32 v25, v26, 1, v25
    v_mul_f32 v76, 0x3ea52b5c, v76
    v_mul_f32 v77, 0x3ea52b5c, v77
    v_mul_f32 v78, 0x3ea52b5c, v78
    v_mul_f32 v79, 0x3ea52b5c, v79
    v_cvt_pk_bf16_f32 v76, v76, v77
    v_cvt_pk_bf16_f32 v77, v78, v79
    v_add_u32 v27, v25, v22
    ds_write_b64 v27, v[76:77]
    v_mul_f32 v92, 0x3ea52b5c, v92
    v_mul_f32 v93, 0x3ea52b5c, v93
    v_mul_f32 v94, 0x3ea52b5c, v94
    v_mul_f32 v95, 0x3ea52b5c, v95
    v_cvt_pk_bf16_f32 v92, v92, v93
    v_cvt_pk_bf16_f32 v93, v94, v95
    v_add_u32 v27, v25, v23
    ds_write_b64 v27, v[92:93]
    s_add_u32 s37, s36, 32
    v_add_u32 v24, s37, v21
    v_mul_u32_u24 v25, 52429, v24
    v_lshrrev_b32 v25, 20, v25
    v_mul_u32_u24 v27, 20, v25
    v_sub_u32 v26, v24, v27
    v_mul_u32_u24 v25, 5120, v25
    v_lshl_add_u32 v25, v26, 1, v25
    v_mul_f32 v96, 0x3ea52b5c, v96
    v_mul_f32 v97, 0x3ea52b5c, v97
    v_mul_f32 v98, 0x3ea52b5c, v98
    v_mul_f32 v99, 0x3ea52b5c, v99
    v_cvt_pk_bf16_f32 v96, v96, v97
    v_cvt_pk_bf16_f32 v97, v98, v99
    v_add_u32 v27, v25, v22
    ds_write_b64 v27, v[96:97]
    v_mul_f32 v112, 0x3ea52b5c, v112
    v_mul_f32 v113, 0x3ea52b5c, v113
    v_mul_f32 v114, 0x3ea52b5c, v114
    v_mul_f32 v115, 0x3ea52b5c, v115
    v_cvt_pk_bf16_f32 v112, v112, v113
    v_cvt_pk_bf16_f32 v113, v114, v115
    v_add_u32 v27, v25, v23
    ds_write_b64 v27, v[112:113]
    s_add_u32 s37, s36, 40
    v_add_u32 v24, s37, v21
    v_mul_u32_u24 v25, 52429, v24
    v_lshrrev_b32 v25, 20, v25
    v_mul_u32_u24 v27, 20, v25
    v_sub_u32 v26, v24, v27
    v_mul_u32_u24 v25, 5120, v25
    v_lshl_add_u32 v25, v26, 1, v25
    v_mul_f32 v100, 0x3ea52b5c, v100
    v_mul_f32 v101, 0x3ea52b5c, v101
    v_mul_f32 v102, 0x3ea52b5c, v102
    v_mul_f32 v103, 0x3ea52b5c, v103
    v_cvt_pk_bf16_f32 v100, v100, v101
    v_cvt_pk_bf16_f32 v101, v102, v103
    v_add_u32 v27, v25, v22
    ds_write_b64 v27, v[100:101]
    v_mul_f32 v116, 0x3ea52b5c, v116
    v_mul_f32 v117, 0x3ea52b5c, v117
    v_mul_f32 v118, 0x3ea52b5c, v118
    v_mul_f32 v119, 0x3ea52b5c, v119
    v_cvt_pk_bf16_f32 v116, v116, v117
    v_cvt_pk_bf16_f32 v117, v118, v119
    v_add_u32 v27, v25, v23
    ds_write_b64 v27, v[116:117]
    s_add_u32 s37, s36, 48
    v_add_u32 v24, s37, v21
    v_mul_u32_u24 v25, 52429, v24
    v_lshrrev_b32 v25, 20, v25
    v_mul_u32_u24 v27, 20, v25
    v_sub_u32 v26, v24, v27
    v_mul_u32_u24 v25, 5120, v25
    v_lshl_add_u32 v25, v26, 1, v25
    v_mul_f32 v104, 0x3ea52b5c, v104
    v_mul_f32 v105, 0x3ea52b5c, v105
    v_mul_f32 v106, 0x3ea52b5c, v106
    v_mul_f32 v107, 0x3ea52b5c, v107
    v_cvt_pk_bf16_f32 v104, v104, v105
    v_cvt_pk_bf16_f32 v105, v106, v107
    v_add_u32 v27, v25, v22
    ds_write_b64 v27, v[104:105]
    v_mul_f32 v120, 0x3ea52b5c, v120
    v_mul_f32 v121, 0x3ea52b5c, v121
    v_mul_f32 v122, 0x3ea52b5c, v122
    v_mul_f32 v123, 0x3ea52b5c, v123
    v_cvt_pk_bf16_f32 v120, v120, v121
    v_cvt_pk_bf16_f32 v121, v122, v123
    v_add_u32 v27, v25, v23
    ds_write_b64 v27, v[120:121]
    s_add_u32 s37, s36, 56
    v_add_u32 v24, s37, v21
    v_mul_u32_u24 v25, 52429, v24
    v_lshrrev_b32 v25, 20, v25
    v_mul_u32_u24 v27, 20, v25
    v_sub_u32 v26, v24, v27
    v_mul_u32_u24 v25, 5120, v25
    v_lshl_add_u32 v25, v26, 1, v25
    v_mul_f32 v108, 0x3ea52b5c, v108
    v_mul_f32 v109, 0x3ea52b5c, v109
    v_mul_f32 v110, 0x3ea52b5c, v110
    v_mul_f32 v111, 0x3ea52b5c, v111
    v_cvt_pk_bf16_f32 v108, v108, v109
    v_cvt_pk_bf16_f32 v109, v110, v111
    v_add_u32 v27, v25, v22
    ds_write_b64 v27, v[108:109]
    v_mul_f32 v124, 0x3ea52b5c, v124
    v_mul_f32 v125, 0x3ea52b5c, v125
    v_mul_f32 v126, 0x3ea52b5c, v126
    v_mul_f32 v127, 0x3ea52b5c, v127
    v_cvt_pk_bf16_f32 v124, v124, v125
    v_cvt_pk_bf16_f32 v125, v126, v127
    v_add_u32 v27, v25, v23
    ds_write_b64 v27, v[124:125]
    s_waitcnt lgkmcnt(0)
    s_barrier
    v_add_u32 v20, 0, v0
    v_mul_u32_u24 v22, 52429, v20
    v_lshrrev_b32 v22, 18, v22
    v_mul_u32_u24 v23, 5, v22
    v_sub_u32 v22, v20, v23
    v_lshlrev_b32 v22, 2, v22
    v_lshlrev_b32 v21, 3, v20
    v_lshlrev_b32 v20, 3, v20
    v_add_u32 v24, 256, v0
    v_mul_u32_u24 v26, 52429, v24
    v_lshrrev_b32 v26, 18, v26
    v_mul_u32_u24 v27, 5, v26
    v_sub_u32 v26, v24, v27
    v_lshlrev_b32 v26, 2, v26
    v_lshlrev_b32 v25, 3, v24
    v_lshlrev_b32 v24, 3, v24
    v_add_u32 v28, 512, v0
    v_mul_u32_u24 v30, 52429, v28
    v_lshrrev_b32 v30, 18, v30
    v_mul_u32_u24 v31, 5, v30
    v_sub_u32 v30, v28, v31
    v_lshlrev_b32 v30, 2, v30
    v_lshlrev_b32 v29, 3, v28
    v_lshlrev_b32 v28, 3, v28
    s_add_u32 s52, s50, 0
    s_lshl_b32 s52, s52, 11
    s_lshl_b32 s53, s24, 7
    s_add_u32 s52, s52, s53
    s_mul_i32 s52, s52, 40
    s_sub_u32 s54, s51, 0
    s_add_u32 s55, s54, 128
    ds_read_b64 v[34:35], v20
    v_cmp_le_i32 vcc, s54, v22
    v_cmp_gt_i32 s[56:57], s55, v22
    s_and_b64 vcc, vcc, s[56:57]
    s_waitcnt lgkmcnt(0)
    s_mov_b64 exec, vcc
    buffer_store_dwordx2 v[34:35], v21, s[44:47], s52 offen
    s_mov_b64 exec, -1
    ds_read_b64 v[34:35], v24
    v_cmp_le_i32 vcc, s54, v26
    v_cmp_gt_i32 s[56:57], s55, v26
    s_and_b64 vcc, vcc, s[56:57]
    s_waitcnt lgkmcnt(0)
    s_mov_b64 exec, vcc
    buffer_store_dwordx2 v[34:35], v25, s[44:47], s52 offen
    s_mov_b64 exec, -1
    ds_read_b64 v[34:35], v28
    v_cmp_le_i32 vcc, s54, v30
    v_cmp_gt_i32 s[56:57], s55, v30
    s_and_b64 vcc, vcc, s[56:57]
    s_movk_i32 s59, 128
    v_cmp_gt_u32 s[56:57], s59, v0
    s_and_b64 vcc, vcc, s[56:57]
    s_waitcnt lgkmcnt(0)
    s_mov_b64 exec, vcc
    buffer_store_dwordx2 v[34:35], v29, s[44:47], s52 offen
    s_mov_b64 exec, -1
    s_add_u32 s52, s50, 1
    s_lshl_b32 s52, s52, 11
    s_lshl_b32 s53, s24, 7
    s_add_u32 s52, s52, s53
    s_mul_i32 s52, s52, 40
    s_sub_u32 s54, s51, 20
    s_add_u32 s55, s54, 128
    ds_read_b64 v[34:35], v20 offset:5120
    v_cmp_le_i32 vcc, s54, v22
    v_cmp_gt_i32 s[56:57], s55, v22
    s_and_b64 vcc, vcc, s[56:57]
    s_waitcnt lgkmcnt(0)
    s_mov_b64 exec, vcc
    buffer_store_dwordx2 v[34:35], v21, s[44:47], s52 offen
    s_mov_b64 exec, -1
    ds_read_b64 v[34:35], v24 offset:5120
    v_cmp_le_i32 vcc, s54, v26
    v_cmp_gt_i32 s[56:57], s55, v26
    s_and_b64 vcc, vcc, s[56:57]
    s_waitcnt lgkmcnt(0)
    s_mov_b64 exec, vcc
    buffer_store_dwordx2 v[34:35], v25, s[44:47], s52 offen
    s_mov_b64 exec, -1
    ds_read_b64 v[34:35], v28 offset:5120
    v_cmp_le_i32 vcc, s54, v30
    v_cmp_gt_i32 s[56:57], s55, v30
    s_and_b64 vcc, vcc, s[56:57]
    s_movk_i32 s59, 128
    v_cmp_gt_u32 s[56:57], s59, v0
    s_and_b64 vcc, vcc, s[56:57]
    s_waitcnt lgkmcnt(0)
    s_mov_b64 exec, vcc
    buffer_store_dwordx2 v[34:35], v29, s[44:47], s52 offen
    s_mov_b64 exec, -1
    s_add_u32 s52, s50, 2
    s_lshl_b32 s52, s52, 11
    s_lshl_b32 s53, s24, 7
    s_add_u32 s52, s52, s53
    s_mul_i32 s52, s52, 40
    s_sub_u32 s54, s51, 40
    s_add_u32 s55, s54, 128
    ds_read_b64 v[34:35], v20 offset:10240
    v_cmp_le_i32 vcc, s54, v22
    v_cmp_gt_i32 s[56:57], s55, v22
    s_and_b64 vcc, vcc, s[56:57]
    s_waitcnt lgkmcnt(0)
    s_mov_b64 exec, vcc
    buffer_store_dwordx2 v[34:35], v21, s[44:47], s52 offen
    s_mov_b64 exec, -1
    ds_read_b64 v[34:35], v24 offset:10240
    v_cmp_le_i32 vcc, s54, v26
    v_cmp_gt_i32 s[56:57], s55, v26
    s_and_b64 vcc, vcc, s[56:57]
    s_waitcnt lgkmcnt(0)
    s_mov_b64 exec, vcc
    buffer_store_dwordx2 v[34:35], v25, s[44:47], s52 offen
    s_mov_b64 exec, -1
    ds_read_b64 v[34:35], v28 offset:10240
    v_cmp_le_i32 vcc, s54, v30
    v_cmp_gt_i32 s[56:57], s55, v30
    s_and_b64 vcc, vcc, s[56:57]
    s_movk_i32 s59, 128
    v_cmp_gt_u32 s[56:57], s59, v0
    s_and_b64 vcc, vcc, s[56:57]
    s_waitcnt lgkmcnt(0)
    s_mov_b64 exec, vcc
    buffer_store_dwordx2 v[34:35], v29, s[44:47], s52 offen
    s_mov_b64 exec, -1
    s_add_u32 s52, s50, 3
    s_lshl_b32 s52, s52, 11
    s_lshl_b32 s53, s24, 7
    s_add_u32 s52, s52, s53
    s_mul_i32 s52, s52, 40
    s_sub_u32 s54, s51, 60
    s_add_u32 s55, s54, 128
    ds_read_b64 v[34:35], v20 offset:15360
    v_cmp_le_i32 vcc, s54, v22
    v_cmp_gt_i32 s[56:57], s55, v22
    s_and_b64 vcc, vcc, s[56:57]
    s_waitcnt lgkmcnt(0)
    s_mov_b64 exec, vcc
    buffer_store_dwordx2 v[34:35], v21, s[44:47], s52 offen
    s_mov_b64 exec, -1
    ds_read_b64 v[34:35], v24 offset:15360
    v_cmp_le_i32 vcc, s54, v26
    v_cmp_gt_i32 s[56:57], s55, v26
    s_and_b64 vcc, vcc, s[56:57]
    s_waitcnt lgkmcnt(0)
    s_mov_b64 exec, vcc
    buffer_store_dwordx2 v[34:35], v25, s[44:47], s52 offen
    s_mov_b64 exec, -1
    ds_read_b64 v[34:35], v28 offset:15360
    v_cmp_le_i32 vcc, s54, v30
    v_cmp_gt_i32 s[56:57], s55, v30
    s_and_b64 vcc, vcc, s[56:57]
    s_movk_i32 s59, 128
    v_cmp_gt_u32 s[56:57], s59, v0
    s_and_b64 vcc, vcc, s[56:57]
    s_waitcnt lgkmcnt(0)
    s_mov_b64 exec, vcc
    buffer_store_dwordx2 v[34:35], v29, s[44:47], s52 offen
    s_mov_b64 exec, -1
    s_add_u32 s52, s50, 4
    s_lshl_b32 s52, s52, 11
    s_lshl_b32 s53, s24, 7
    s_add_u32 s52, s52, s53
    s_mul_i32 s52, s52, 40
    s_sub_u32 s54, s51, 80
    s_add_u32 s55, s54, 128
    ds_read_b64 v[34:35], v20 offset:20480
    v_cmp_le_i32 vcc, s54, v22
    v_cmp_gt_i32 s[56:57], s55, v22
    s_and_b64 vcc, vcc, s[56:57]
    s_waitcnt lgkmcnt(0)
    s_mov_b64 exec, vcc
    buffer_store_dwordx2 v[34:35], v21, s[44:47], s52 offen
    s_mov_b64 exec, -1
    ds_read_b64 v[34:35], v24 offset:20480
    v_cmp_le_i32 vcc, s54, v26
    v_cmp_gt_i32 s[56:57], s55, v26
    s_and_b64 vcc, vcc, s[56:57]
    s_waitcnt lgkmcnt(0)
    s_mov_b64 exec, vcc
    buffer_store_dwordx2 v[34:35], v25, s[44:47], s52 offen
    s_mov_b64 exec, -1
    ds_read_b64 v[34:35], v28 offset:20480
    v_cmp_le_i32 vcc, s54, v30
    v_cmp_gt_i32 s[56:57], s55, v30
    s_and_b64 vcc, vcc, s[56:57]
    s_movk_i32 s59, 128
    v_cmp_gt_u32 s[56:57], s59, v0
    s_and_b64 vcc, vcc, s[56:57]
    s_waitcnt lgkmcnt(0)
    s_mov_b64 exec, vcc
    buffer_store_dwordx2 v[34:35], v29, s[44:47], s52 offen
    s_mov_b64 exec, -1
    s_add_u32 s52, s50, 5
    s_lshl_b32 s52, s52, 11
    s_lshl_b32 s53, s24, 7
    s_add_u32 s52, s52, s53
    s_mul_i32 s52, s52, 40
    s_sub_u32 s54, s51, 100
    s_add_u32 s55, s54, 128
    ds_read_b64 v[34:35], v20 offset:25600
    v_cmp_le_i32 vcc, s54, v22
    v_cmp_gt_i32 s[56:57], s55, v22
    s_and_b64 vcc, vcc, s[56:57]
    s_waitcnt lgkmcnt(0)
    s_mov_b64 exec, vcc
    buffer_store_dwordx2 v[34:35], v21, s[44:47], s52 offen
    s_mov_b64 exec, -1
    ds_read_b64 v[34:35], v24 offset:25600
    v_cmp_le_i32 vcc, s54, v26
    v_cmp_gt_i32 s[56:57], s55, v26
    s_and_b64 vcc, vcc, s[56:57]
    s_waitcnt lgkmcnt(0)
    s_mov_b64 exec, vcc
    buffer_store_dwordx2 v[34:35], v25, s[44:47], s52 offen
    s_mov_b64 exec, -1
    ds_read_b64 v[34:35], v28 offset:25600
    v_cmp_le_i32 vcc, s54, v30
    v_cmp_gt_i32 s[56:57], s55, v30
    s_and_b64 vcc, vcc, s[56:57]
    s_movk_i32 s59, 128
    v_cmp_gt_u32 s[56:57], s59, v0
    s_and_b64 vcc, vcc, s[56:57]
    s_waitcnt lgkmcnt(0)
    s_mov_b64 exec, vcc
    buffer_store_dwordx2 v[34:35], v29, s[44:47], s52 offen
    s_mov_b64 exec, -1
    s_add_u32 s52, s50, 6
    s_lshl_b32 s52, s52, 11
    s_lshl_b32 s53, s24, 7
    s_add_u32 s52, s52, s53
    s_mul_i32 s52, s52, 40
    s_sub_u32 s54, s51, 120
    s_add_u32 s55, s54, 128
    ds_read_b64 v[34:35], v20 offset:30720
    v_cmp_le_i32 vcc, s54, v22
    v_cmp_gt_i32 s[56:57], s55, v22
    s_and_b64 vcc, vcc, s[56:57]
    s_waitcnt lgkmcnt(0)
    s_mov_b64 exec, vcc
    buffer_store_dwordx2 v[34:35], v21, s[44:47], s52 offen
    s_mov_b64 exec, -1
    ds_read_b64 v[34:35], v24 offset:30720
    v_cmp_le_i32 vcc, s54, v26
    v_cmp_gt_i32 s[56:57], s55, v26
    s_and_b64 vcc, vcc, s[56:57]
    s_waitcnt lgkmcnt(0)
    s_mov_b64 exec, vcc
    buffer_store_dwordx2 v[34:35], v25, s[44:47], s52 offen
    s_mov_b64 exec, -1
    ds_read_b64 v[34:35], v28 offset:30720
    v_cmp_le_i32 vcc, s54, v30
    v_cmp_gt_i32 s[56:57], s55, v30
    s_and_b64 vcc, vcc, s[56:57]
    s_movk_i32 s59, 128
    v_cmp_gt_u32 s[56:57], s59, v0
    s_and_b64 vcc, vcc, s[56:57]
    s_waitcnt lgkmcnt(0)
    s_mov_b64 exec, vcc
    buffer_store_dwordx2 v[34:35], v29, s[44:47], s52 offen
    s_mov_b64 exec, -1
    s_add_u32 s52, s50, 7
    s_lshl_b32 s52, s52, 11
    s_lshl_b32 s53, s24, 7
    s_add_u32 s52, s52, s53
    s_mul_i32 s52, s52, 40
    s_sub_u32 s54, s51, 140
    s_add_u32 s55, s54, 128
    ds_read_b64 v[34:35], v20 offset:35840
    v_cmp_le_i32 vcc, s54, v22
    v_cmp_gt_i32 s[56:57], s55, v22
    s_and_b64 vcc, vcc, s[56:57]
    s_waitcnt lgkmcnt(0)
    s_mov_b64 exec, vcc
    buffer_store_dwordx2 v[34:35], v21, s[44:47], s52 offen
    s_mov_b64 exec, -1
    ds_read_b64 v[34:35], v24 offset:35840
    v_cmp_le_i32 vcc, s54, v26
    v_cmp_gt_i32 s[56:57], s55, v26
    s_and_b64 vcc, vcc, s[56:57]
    s_waitcnt lgkmcnt(0)
    s_mov_b64 exec, vcc
    buffer_store_dwordx2 v[34:35], v25, s[44:47], s52 offen
    s_mov_b64 exec, -1
    ds_read_b64 v[34:35], v28 offset:35840
    v_cmp_le_i32 vcc, s54, v30
    v_cmp_gt_i32 s[56:57], s55, v30
    s_and_b64 vcc, vcc, s[56:57]
    s_movk_i32 s59, 128
    v_cmp_gt_u32 s[56:57], s59, v0
    s_and_b64 vcc, vcc, s[56:57]
    s_waitcnt lgkmcnt(0)
    s_mov_b64 exec, vcc
    buffer_store_dwordx2 v[34:35], v29, s[44:47], s52 offen
    s_mov_b64 exec, -1
    s_branch L_mha_qkv_kernel_qkdone
L_mha_qkv_kernel_kpart:
    s_lshl_b32 s51, s25, 7
    s_sub_u32 s51, s51, 640
    s_mul_i32 s50, s51, 52429
    s_lshr_b32 s50, s50, 20
    s_mul_i32 s52, s50, 20
    s_sub_u32 s51, s51, s52
    s_add_u32 s36, s36, s51
    v_add_u32 v24, 0, v20
    v_lshrrev_b32 v25, 6, v24
    v_mul_u32_u24 v25, 2560, v25
    v_bfe_u32 v26, v24, 5, 1
    v_and_b32 v27, 31, v24
    v_lshlrev_b32 v28, 10, v26
    v_add_u32 v28, v28, v25
    v_lshl_add_u32 v22, v27, 4, v28
    v_lshlrev_b32 v28, 8, v26
    v_add_u32 v28, v28, v25
    v_lshl_add_u32 v28, v27, 3, v28
    v_add_u32 v30, 2048, v28
    v_add_u32 v24, 32, v20
    v_lshrrev_b32 v25, 6, v24
    v_mul_u32_u24 v25, 2560, v25
    v_bfe_u32 v26, v24, 5, 1
    v_and_b32 v27, 31, v24
    v_lshlrev_b32 v28, 10, v26
    v_add_u32 v28, v28, v25
    v_lshl_add_u32 v23, v27, 4, v28
    v_lshlrev_b32 v28, 8, v26
    v_add_u32 v28, v28, v25
    v_lshl_add_u32 v28, v27, 3, v28
    v_add_u32 v31, 2048, v28
    s_add_u32 s37, s36, 0
    v_add_u32 v24, s37, v21
    v_mul_u32_u24 v25, 52429, v24
    v_lshrrev_b32 v25, 20, v25
    v_mul_u32_u24 v27, 20, v25
    v_sub_u32 v26, v24, v27
    v_mul_u32_u24 v25, 5120, v25
    v_lshrrev_b32 v27, 3, v26
    v_lshlrev_b32 v27, 9, v27
    v_and_b32 v28, 7, v26
    v_lshl_add_u32 v27, v28, 1, v27
    v_cmp_gt_u32 vcc, 16, v26
    s_nop 1
    v_add_u32 v28, v27, v22
    v_cndmask_b32 v28, v30, v28, vcc
    v_add_u32 v28, v28, v25
    v_cvt_pk_bf16_f32 v64, v64, v65
    v_cvt_pk_bf16_f32 v65, v66, v67
    ds_write_b64 v28, v[64:65]
    v_add_u32 v28, v27, v23
    v_cndmask_b32 v28, v31, v28, vcc
    v_add_u32 v28, v28, v25
    v_cvt_pk_bf16_f32 v80, v80, v81
    v_cvt_pk_bf16_f32 v81, v82, v83
    ds_write_b64 v28, v[80:81]
    s_add_u32 s37, s36, 8
    v_add_u32 v24, s37, v21
    v_mul_u32_u24 v25, 52429, v24
    v_lshrrev_b32 v25, 20, v25
    v_mul_u32_u24 v27, 20, v25
    v_sub_u32 v26, v24, v27
    v_mul_u32_u24 v25, 5120, v25
    v_lshrrev_b32 v27, 3, v26
    v_lshlrev_b32 v27, 9, v27
    v_and_b32 v28, 7, v26
    v_lshl_add_u32 v27, v28, 1, v27
    v_cmp_gt_u32 vcc, 16, v26
    s_nop 1
    v_add_u32 v28, v27, v22
    v_cndmask_b32 v28, v30, v28, vcc
    v_add_u32 v28, v28, v25
    v_cvt_pk_bf16_f32 v68, v68, v69
    v_cvt_pk_bf16_f32 v69, v70, v71
    ds_write_b64 v28, v[68:69]
    v_add_u32 v28, v27, v23
    v_cndmask_b32 v28, v31, v28, vcc
    v_add_u32 v28, v28, v25
    v_cvt_pk_bf16_f32 v84, v84, v85
    v_cvt_pk_bf16_f32 v85, v86, v87
    ds_write_b64 v28, v[84:85]
    s_add_u32 s37, s36, 16
    v_add_u32 v24, s37, v21
    v_mul_u32_u24 v25, 52429, v24
    v_lshrrev_b32 v25, 20, v25
    v_mul_u32_u24 v27, 20, v25
    v_sub_u32 v26, v24, v27
    v_mul_u32_u24 v25, 5120, v25
    v_lshrrev_b32 v27, 3, v26
    v_lshlrev_b32 v27, 9, v27
    v_and_b32 v28, 7, v26
    v_lshl_add_u32 v27, v28, 1, v27
    v_cmp_gt_u32 vcc, 16, v26
    s_nop 1
    v_add_u32 v28, v27, v22
    v_cndmask_b32 v28, v30, v28, vcc
    v_add_u32 v28, v28, v25
    v_cvt_pk_bf16_f32 v72, v72, v73
    v_cvt_pk_bf16_f32 v73, v74, v75
    ds_write_b64 v28, v[72:73]
    v_add_u32 v28, v27, v23
    v_cndmask_b32 v28, v31, v28, vcc
    v_add_u32 v28, v28, v25
    v_cvt_pk_bf16_f32 v88, v88, v89
    v_cvt_pk_bf16_f32 v89, v90, v91
    ds_write_b64 v28, v[88:89]
    s_add_u32 s37, s36, 24
    v_add_u32 v24, s37, v21
    v_mul_u32_u24 v25, 52429, v24
    v_lshrrev_b32 v25, 20, v25
    v_mul_u32_u24 v27, 20, v25
    v_sub_u32 v26, v24, v27
    v_mul_u32_u24 v25, 5120, v25
    v_lshrrev_b32 v27, 3, v26
    v_lshlrev_b32 v27, 9, v27
    v_and_b32 v28, 7, v26
    v_lshl_add_u32 v27, v28, 1, v27
    v_cmp_gt_u32 vcc, 16, v26
    s_nop 1
    v_add_u32 v28, v27, v22
    v_cndmask_b32 v28, v30, v28, vcc
    v_add_u32 v28, v28, v25
    v_cvt_pk_bf16_f32 v76, v76, v77
    v_cvt_pk_bf16_f32 v77, v78, v79
    ds_write_b64 v28, v[76:77]
    v_add_u32 v28, v27, v23
    v_cndmask_b32 v28, v31, v28, vcc
    v_add_u32 v28, v28, v25
    v_cvt_pk_bf16_f32 v92, v92, v93
    v_cvt_pk_bf16_f32 v93, v94, v95
    ds_write_b64 v28, v[92:93]
    s_add_u32 s37, s36, 32
    v_add_u32 v24, s37, v21
    v_mul_u32_u24 v25, 52429, v24
    v_lshrrev_b32 v25, 20, v25
    v_mul_u32_u24 v27, 20, v25
    v_sub_u32 v26, v24, v27
    v_mul_u32_u24 v25, 5120, v25
    v_lshrrev_b32 v27, 3, v26
    v_lshlrev_b32 v27, 9, v27
    v_and_b32 v28, 7, v26
    v_lshl_add_u32 v27, v28, 1, v27
    v_cmp_gt_u32 vcc, 16, v26
    s_nop 1
    v_add_u32 v28, v27, v22
    v_cndmask_b32 v28, v30, v28, vcc
    v_add_u32 v28, v28, v25
    v_cvt_pk_bf16_f32 v96, v96, v97
    v_cvt_pk_bf16_f32 v97, v98, v99
    ds_write_b64 v28, v[96:97]
    v_add_u32 v28, v27, v23
    v_cndmask_b32 v28, v31, v28, vcc
    v_add_u32 v28, v28, v25
    v_cvt_pk_bf16_f32 v112, v112, v113
    v_cvt_pk_bf16_f32 v113, v114, v115
    ds_write_b64 v28, v[112:113]
    s_add_u32 s37, s36, 40
    v_add_u32 v24, s37, v21
    v_mul_u32_u24 v25, 52429, v24
    v_lshrrev_b32 v25, 20, v25
    v_mul_u32_u24 v27, 20, v25
    v_sub_u32 v26, v24, v27
    v_mul_u32_u24 v25, 5120, v25
    v_lshrrev_b32 v27, 3, v26
    v_lshlrev_b32 v27, 9, v27
    v_and_b32 v28, 7, v26
    v_lshl_add_u32 v27, v28, 1, v27
    v_cmp_gt_u32 vcc, 16, v26
    s_nop 1
    v_add_u32 v28, v27, v22
    v_cndmask_b32 v28, v30, v28, vcc
    v_add_u32 v28, v28, v25
    v_cvt_pk_bf16_f32 v100, v100, v101
    v_cvt_pk_bf16_f32 v101, v102, v103
    ds_write_b64 v28, v[100:101]
    v_add_u32 v28, v27, v23
    v_cndmask_b32 v28, v31, v28, vcc
    v_add_u32 v28, v28, v25
    v_cvt_pk_bf16_f32 v116, v116, v117
    v_cvt_pk_bf16_f32 v117, v118, v119
    ds_write_b64 v28, v[116:117]
    s_add_u32 s37, s36, 48
    v_add_u32 v24, s37, v21
    v_mul_u32_u24 v25, 52429, v24
    v_lshrrev_b32 v25, 20, v25
    v_mul_u32_u24 v27, 20, v25
    v_sub_u32 v26, v24, v27
    v_mul_u32_u24 v25, 5120, v25
    v_lshrrev_b32 v27, 3, v26
    v_lshlrev_b32 v27, 9, v27
    v_and_b32 v28, 7, v26
    v_lshl_add_u32 v27, v28, 1, v27
    v_cmp_gt_u32 vcc, 16, v26
    s_nop 1
    v_add_u32 v28, v27, v22
    v_cndmask_b32 v28, v30, v28, vcc
    v_add_u32 v28, v28, v25
    v_cvt_pk_bf16_f32 v104, v104, v105
    v_cvt_pk_bf16_f32 v105, v106, v107
    ds_write_b64 v28, v[104:105]
    v_add_u32 v28, v27, v23
    v_cndmask_b32 v28, v31, v28, vcc
    v_add_u32 v28, v28, v25
    v_cvt_pk_bf16_f32 v120, v120, v121
    v_cvt_pk_bf16_f32 v121, v122, v123
    ds_write_b64 v28, v[120:121]
    s_add_u32 s37, s36, 56
    v_add_u32 v24, s37, v21
    v_mul_u32_u24 v25, 52429, v24
    v_lshrrev_b32 v25, 20, v25
    v_mul_u32_u24 v27, 20, v25
    v_sub_u32 v26, v24, v27
    v_mul_u32_u24 v25, 5120, v25
    v_lshrrev_b32 v27, 3, v26
    v_lshlrev_b32 v27, 9, v27
    v_and_b32 v28, 7, v26
    v_lshl_add_u32 v27, v28, 1, v27
    v_cmp_gt_u32 vcc, 16, v26
    s_nop 1
    v_add_u32 v28, v27, v22
    v_cndmask_b32 v28, v30, v28, vcc
    v_add_u32 v28, v28, v25
    v_cvt_pk_bf16_f32 v108, v108, v109
    v_cvt_pk_bf16_f32 v109, v110, v111
    ds_write_b64 v28, v[108:109]
    v_add_u32 v28, v27, v23
    v_cndmask_b32 v28, v31, v28, vcc
    v_add_u32 v28, v28, v25
    v_cvt_pk_bf16_f32 v124, v124, v125
    v_cvt_pk_bf16_f32 v125, v126, v127
    ds_write_b64 v28, v[124:125]
    s_waitcnt lgkmcnt(0)
    s_barrier
    v_add_u32 v20, 0, v0
    v_mul_u32_u24 v22, 13108, v20
    v_lshrrev_b32 v22, 22, v22
    v_mul_u32_u24 v23, 320, v22
    v_sub_u32 v23, v20, v23
    v_mul_u32_u24 v21, 5120, v22
    v_lshl_add_u32 v21, v23, 3, v21
    v_bfe_u32 v22, v23, 6, 1
    v_lshlrev_b32 v22, 3, v22
    v_and_b32 v32, 1, v23
    v_lshl_add_u32 v22, v32, 2, v22
    v_cmp_gt_u32 vcc, 256, v23
    v_mov_b32 v32, 16
    s_nop 0
    v_cndmask_b32 v22, v32, v22, vcc
    v_lshlrev_b32 v20, 3, v20
    v_add_u32 v24, 256, v0
    v_mul_u32_u24 v26, 13108, v24
    v_lshrrev_b32 v26, 22, v26
    v_mul_u32_u24 v27, 320, v26
    v_sub_u32 v27, v24, v27
    v_mul_u32_u24 v25, 5120, v26
    v_lshl_add_u32 v25, v27, 3, v25
    v_bfe_u32 v26, v27, 6, 1
    v_lshlrev_b32 v26, 3, v26
    v_and_b32 v32, 1, v27
    v_lshl_add_u32 v26, v32, 2, v26
    v_cmp_gt_u32 vcc, 256, v27
    v_mov_b32 v32, 16
    s_nop 0
    v_cndmask_b32 v26, v32, v26, vcc
    v_lshlrev_b32 v24, 3, v24
    v_add_u32 v28, 512, v0
    v_mul_u32_u24 v30, 13108, v28
    v_lshrrev_b32 v30, 22, v30
    v_mul_u32_u24 v31, 320, v30
    v_sub_u32 v31, v28, v31
    v_mul_u32_u24 v29, 5120, v30
    v_lshl_add_u32 v29, v31, 3, v29
    v_bfe_u32 v30, v31, 6, 1
    v_lshlrev_b32 v30, 3, v30
    v_and_b32 v32, 1, v31
    v_lshl_add_u32 v30, v32, 2, v30
    v_cmp_gt_u32 vcc, 256, v31
    v_mov_b32 v32, 16
    s_nop 0
    v_cndmask_b32 v30, v32, v30, vcc
    v_lshlrev_b32 v28, 3, v28
    s_add_u32 s52, s50, 0
    s_mul_i32 s52, s52, 163840
    s_lshl_b32 s53, s24, 1
    s_mul_i32 s53, s53, 5120
    s_add_u32 s52, s52, s53
    s_add_u32 s52, s52, 4194304
    s_sub_u32 s54, s51, 0
    s_add_u32 s55, s54, 128
    ds_read_b64 v[34:35], v20
    v_cmp_le_i32 vcc, s54, v22
    v_cmp_gt_i32 s[56:57], s55, v22
    s_and_b64 vcc, vcc, s[56:57]
    s_waitcnt lgkmcnt(0)
    s_mov_b64 exec, vcc
    buffer_store_dwordx2 v[34:35], v21, s[44:47], s52 offen
    s_mov_b64 exec, -1
    ds_read_b64 v[34:35], v24
    v_cmp_le_i32 vcc, s54, v26
    v_cmp_gt_i32 s[56:57], s55, v26
    s_and_b64 vcc, vcc, s[56:57]
    s_waitcnt lgkmcnt(0)
    s_mov_b64 exec, vcc
    buffer_store_dwordx2 v[34:35], v25, s[44:47], s52 offen
    s_mov_b64 exec, -1
    ds_read_b64 v[34:35], v28
    v_cmp_le_i32 vcc, s54, v30
    v_cmp_gt_i32 s[56:57], s55, v30
    s_and_b64 vcc, vcc, s[56:57]
    s_movk_i32 s59, 128
    v_cmp_gt_u32 s[56:57], s59, v0
    s_and_b64 vcc, vcc, s[56:57]
    s_waitcnt lgkmcnt(0)
    s_mov_b64 exec, vcc
    buffer_store_dwordx2 v[34:35], v29, s[44:47], s52 offen
    s_mov_b64 exec, -1
    s_add_u32 s52, s50, 1
    s_mul_i32 s52, s52, 163840
    s_lshl_b32 s53, s24, 1
    s_mul_i32 s53, s53, 5120
    s_add_u32 s52, s52, s53
    s_add_u32 s52, s52, 4194304
    s_sub_u32 s54, s51, 20
    s_add_u32 s55, s54, 128
    ds_read_b64 v[34:35], v20 offset:5120
    v_cmp_le_i32 vcc, s54, v22
    v_cmp_gt_i32 s[56:57], s55, v22
    s_and_b64 vcc, vcc, s[56:57]
    s_waitcnt lgkmcnt(0)
    s_mov_b64 exec, vcc
    buffer_store_dwordx2 v[34:35], v21, s[44:47], s52 offen
    s_mov_b64 exec, -1
    ds_read_b64 v[34:35], v24 offset:5120
    v_cmp_le_i32 vcc, s54, v26
    v_cmp_gt_i32 s[56:57], s55, v26
    s_and_b64 vcc, vcc, s[56:57]
    s_waitcnt lgkmcnt(0)
    s_mov_b64 exec, vcc
    buffer_store_dwordx2 v[34:35], v25, s[44:47], s52 offen
    s_mov_b64 exec, -1
    ds_read_b64 v[34:35], v28 offset:5120
    v_cmp_le_i32 vcc, s54, v30
    v_cmp_gt_i32 s[56:57], s55, v30
    s_and_b64 vcc, vcc, s[56:57]
    s_movk_i32 s59, 128
    v_cmp_gt_u32 s[56:57], s59, v0
    s_and_b64 vcc, vcc, s[56:57]
    s_waitcnt lgkmcnt(0)
    s_mov_b64 exec, vcc
    buffer_store_dwordx2 v[34:35], v29, s[44:47], s52 offen
    s_mov_b64 exec, -1
    s_add_u32 s52, s50, 2
    s_mul_i32 s52, s52, 163840
    s_lshl_b32 s53, s24, 1
    s_mul_i32 s53, s53, 5120
    s_add_u32 s52, s52, s53
    s_add_u32 s52, s52, 4194304
    s_sub_u32 s54, s51, 40
    s_add_u32 s55, s54, 128
    ds_read_b64 v[34:35], v20 offset:10240
    v_cmp_le_i32 vcc, s54, v22
    v_cmp_gt_i32 s[56:57], s55, v22
    s_and_b64 vcc, vcc, s[56:57]
    s_waitcnt lgkmcnt(0)
    s_mov_b64 exec, vcc
    buffer_store_dwordx2 v[34:35], v21, s[44:47], s52 offen
    s_mov_b64 exec, -1
    ds_read_b64 v[34:35], v24 offset:10240
    v_cmp_le_i32 vcc, s54, v26
    v_cmp_gt_i32 s[56:57], s55, v26
    s_and_b64 vcc, vcc, s[56:57]
    s_waitcnt lgkmcnt(0)
    s_mov_b64 exec, vcc
    buffer_store_dwordx2 v[34:35], v25, s[44:47], s52 offen
    s_mov_b64 exec, -1
    ds_read_b64 v[34:35], v28 offset:10240
    v_cmp_le_i32 vcc, s54, v30
    v_cmp_gt_i32 s[56:57], s55, v30
    s_and_b64 vcc, vcc, s[56:57]
    s_movk_i32 s59, 128
    v_cmp_gt_u32 s[56:57], s59, v0
    s_and_b64 vcc, vcc, s[56:57]
    s_waitcnt lgkmcnt(0)
    s_mov_b64 exec, vcc
    buffer_store_dwordx2 v[34:35], v29, s[44:47], s52 offen
    s_mov_b64 exec, -1
    s_add_u32 s52, s50, 3
    s_mul_i32 s52, s52, 163840
    s_lshl_b32 s53, s24, 1
    s_mul_i32 s53, s53, 5120
    s_add_u32 s52, s52, s53
    s_add_u32 s52, s52, 4194304
    s_sub_u32 s54, s51, 60
    s_add_u32 s55, s54, 128
    ds_read_b64 v[34:35], v20 offset:15360
    v_cmp_le_i32 vcc, s54, v22
    v_cmp_gt_i32 s[56:57], s55, v22
    s_and_b64 vcc, vcc, s[56:57]
    s_waitcnt lgkmcnt(0)
    s_mov_b64 exec, vcc
    buffer_store_dwordx2 v[34:35], v21, s[44:47], s52 offen
    s_mov_b64 exec, -1
    ds_read_b64 v[34:35], v24 offset:15360
    v_cmp_le_i32 vcc, s54, v26
    v_cmp_gt_i32 s[56:57], s55, v26
    s_and_b64 vcc, vcc, s[56:57]
    s_waitcnt lgkmcnt(0)
    s_mov_b64 exec, vcc
    buffer_store_dwordx2 v[34:35], v25, s[44:47], s52 offen
    s_mov_b64 exec, -1
    ds_read_b64 v[34:35], v28 offset:15360
    v_cmp_le_i32 vcc, s54, v30
    v_cmp_gt_i32 s[56:57], s55, v30
    s_and_b64 vcc, vcc, s[56:57]
    s_movk_i32 s59, 128
    v_cmp_gt_u32 s[56:57], s59, v0
    s_and_b64 vcc, vcc, s[56:57]
    s_waitcnt lgkmcnt(0)
    s_mov_b64 exec, vcc
    buffer_store_dwordx2 v[34:35], v29, s[44:47], s52 offen
    s_mov_b64 exec, -1
    s_add_u32 s52, s50, 4
    s_mul_i32 s52, s52, 163840
    s_lshl_b32 s53, s24, 1
    s_mul_i32 s53, s53, 5120
    s_add_u32 s52, s52, s53
    s_add_u32 s52, s52, 4194304
    s_sub_u32 s54, s51, 80
    s_add_u32 s55, s54, 128
    ds_read_b64 v[34:35], v20 offset:20480
    v_cmp_le_i32 vcc, s54, v22
    v_cmp_gt_i32 s[56:57], s55, v22
    s_and_b64 vcc, vcc, s[56:57]
    s_waitcnt lgkmcnt(0)
    s_mov_b64 exec, vcc
    buffer_store_dwordx2 v[34:35], v21, s[44:47], s52 offen
    s_mov_b64 exec, -1
    ds_read_b64 v[34:35], v24 offset:20480
    v_cmp_le_i32 vcc, s54, v26
    v_cmp_gt_i32 s[56:57], s55, v26
    s_and_b64 vcc, vcc, s[56:57]
    s_waitcnt lgkmcnt(0)
    s_mov_b64 exec, vcc
    buffer_store_dwordx2 v[34:35], v25, s[44:47], s52 offen
    s_mov_b64 exec, -1
    ds_read_b64 v[34:35], v28 offset:20480
    v_cmp_le_i32 vcc, s54, v30
    v_cmp_gt_i32 s[56:57], s55, v30
    s_and_b64 vcc, vcc, s[56:57]
    s_movk_i32 s59, 128
    v_cmp_gt_u32 s[56:57], s59, v0
    s_and_b64 vcc, vcc, s[56:57]
    s_waitcnt lgkmcnt(0)
    s_mov_b64 exec, vcc
    buffer_store_dwordx2 v[34:35], v29, s[44:47], s52 offen
    s_mov_b64 exec, -1
    s_add_u32 s52, s50, 5
    s_mul_i32 s52, s52, 163840
    s_lshl_b32 s53, s24, 1
    s_mul_i32 s53, s53, 5120
    s_add_u32 s52, s52, s53
    s_add_u32 s52, s52, 4194304
    s_sub_u32 s54, s51, 100
    s_add_u32 s55, s54, 128
    ds_read_b64 v[34:35], v20 offset:25600
    v_cmp_le_i32 vcc, s54, v22
    v_cmp_gt_i32 s[56:57], s55, v22
    s_and_b64 vcc, vcc, s[56:57]
    s_waitcnt lgkmcnt(0)
    s_mov_b64 exec, vcc
    buffer_store_dwordx2 v[34:35], v21, s[44:47], s52 offen
    s_mov_b64 exec, -1
    ds_read_b64 v[34:35], v24 offset:25600
    v_cmp_le_i32 vcc, s54, v26
    v_cmp_gt_i32 s[56:57], s55, v26
    s_and_b64 vcc, vcc, s[56:57]
    s_waitcnt lgkmcnt(0)
    s_mov_b64 exec, vcc
    buffer_store_dwordx2 v[34:35], v25, s[44:47], s52 offen
    s_mov_b64 exec, -1
    ds_read_b64 v[34:35], v28 offset:25600
    v_cmp_le_i32 vcc, s54, v30
    v_cmp_gt_i32 s[56:57], s55, v30
    s_and_b64 vcc, vcc, s[56:57]
    s_movk_i32 s59, 128
    v_cmp_gt_u32 s[56:57], s59, v0
    s_and_b64 vcc, vcc, s[56:57]
    s_waitcnt lgkmcnt(0)
    s_mov_b64 exec, vcc
    buffer_store_dwordx2 v[34:35], v29, s[44:47], s52 offen
    s_mov_b64 exec, -1
    s_add_u32 s52, s50, 6
    s_mul_i32 s52, s52, 163840
    s_lshl_b32 s53, s24, 1
    s_mul_i32 s53, s53, 5120
    s_add_u32 s52, s52, s53
    s_add_u32 s52, s52, 4194304
    s_sub_u32 s54, s51, 120
    s_add_u32 s55, s54, 128
    ds_read_b64 v[34:35], v20 offset:30720
    v_cmp_le_i32 vcc, s54, v22
    v_cmp_gt_i32 s[56:57], s55, v22
    s_and_b64 vcc, vcc, s[56:57]
    s_waitcnt lgkmcnt(0)
    s_mov_b64 exec, vcc
    buffer_store_dwordx2 v[34:35], v21, s[44:47], s52 offen
    s_mov_b64 exec, -1
    ds_read_b64 v[34:35], v24 offset:30720
    v_cmp_le_i32 vcc, s54, v26
    v_cmp_gt_i32 s[56:57], s55, v26
    s_and_b64 vcc, vcc, s[56:57]
    s_waitcnt lgkmcnt(0)
    s_mov_b64 exec, vcc
    buffer_store_dwordx2 v[34:35], v25, s[44:47], s52 offen
    s_mov_b64 exec, -1
    ds_read_b64 v[34:35], v28 offset:30720
    v_cmp_le_i32 vcc, s54, v30
    v_cmp_gt_i32 s[56:57], s55, v30
    s_and_b64 vcc, vcc, s[56:57]
    s_movk_i32 s59, 128
    v_cmp_gt_u32 s[56:57], s59, v0
    s_and_b64 vcc, vcc, s[56:57]
    s_waitcnt lgkmcnt(0)
    s_mov_b64 exec, vcc
    buffer_store_dwordx2 v[34:35], v29, s[44:47], s52 offen
    s_mov_b64 exec, -1
    s_add_u32 s52, s50, 7
    s_mul_i32 s52, s52, 163840
    s_lshl_b32 s53, s24, 1
    s_mul_i32 s53, s53, 5120
    s_add_u32 s52, s52, s53
    s_add_u32 s52, s52, 4194304
    s_sub_u32 s54, s51, 140
    s_add_u32 s55, s54, 128
    ds_read_b64 v[34:35], v20 offset:35840
    v_cmp_le_i32 vcc, s54, v22
    v_cmp_gt_i32 s[56:57], s55, v22
    s_and_b64 vcc, vcc, s[56:57]
    s_waitcnt lgkmcnt(0)
    s_mov_b64 exec, vcc
    buffer_store_dwordx2 v[34:35], v21, s[44:47], s52 offen
    s_mov_b64 exec, -1
    ds_read_b64 v[34:35], v24 offset:35840
    v_cmp_le_i32 vcc, s54, v26
    v_cmp_gt_i32 s[56:57], s55, v26
    s_and_b64 vcc, vcc, s[56:57]
    s_waitcnt lgkmcnt(0)
    s_mov_b64 exec, vcc
    buffer_store_dwordx2 v[34:35], v25, s[44:47], s52 offen
    s_mov_b64 exec, -1
    ds_read_b64 v[34:35], v28 offset:35840
    v_cmp_le_i32 vcc, s54, v30
    v_cmp_gt_i32 s[56:57], s55, v30
    s_and_b64 vcc, vcc, s[56:57]
    s_movk_i32 s59, 128
    v_cmp_gt_u32 s[56:57], s59, v0
    s_and_b64 vcc, vcc, s[56:57]
    s_waitcnt lgkmcnt(0)
    s_mov_b64 exec, vcc
    buffer_store_dwordx2 v[34:35], v29, s[44:47], s52 offen
    s_mov_b64 exec, -1
L_mha_qkv_kernel_qkdone:
    s_waitcnt vmcnt(0)
    s_branch L_mha_qkv_kernel_end
L_mha_qkv_kernel_v:
    s_waitcnt vmcnt(16)
    s_barrier
    ds_read_b128 v[32:35], v8
    ds_read_b128 v[36:39], v8 offset:4096
    ds_read_b64_tr_b16 v[48:49], v16 offset:16384
    ds_read_b64_tr_b16 v[50:51], v16 offset:17408
    ds_read_b64_tr_b16 v[52:53], v17 offset:16384
    ds_read_b64_tr_b16 v[54:55], v17 offset:17408
    ds_read_b128 v[40:43], v9
    ds_read_b128 v[44:47], v9 offset:4096
    ds_read_b64_tr_b16 v[56:57], v16 offset:20480
    ds_read_b64_tr_b16 v[58:59], v16 offset:21504
    ds_read_b64_tr_b16 v[60:61], v17 offset:20480
    ds_read_b64_tr_b16 v[62:63], v17 offset:21504
    s_waitcnt lgkmcnt(6)
    v_mfma_f32_32x32x16_bf16 v[64:79], v[32:35], v[48:51], v[64:79]
    s_add_u32 m0, s33, 98304
    s_add_u32 s35, s30, 384
    buffer_load_dwordx4 v2, s[12:15], s35 offen lds
    v_mfma_f32_32x32x16_bf16 v[80:95], v[32:35], v[52:55], v[80:95]
    v_mfma_f32_32x32x16_bf16 v[96:111], v[36:39], v[48:51], v[96:111]
    s_add_u32 m0, s33, 99328
    s_add_u32 s35, s30, 10624
    buffer_load_dwordx4 v3, s[12:15], s35 offen lds
    v_mfma_f32_32x32x16_bf16 v[112:127], v[36:39], v[52:55], v[112:127]
    ds_read_b128 v[32:35], v10
    ds_read_b128 v[36:39], v10 offset:4096
    ds_read_b64_tr_b16 v[48:49], v16 offset:24576
    ds_read_b64_tr_b16 v[50:51], v16 offset:25600
    ds_read_b64_tr_b16 v[52:53], v17 offset:24576
    ds_read_b64_tr_b16 v[54:55], v17 offset:25600
    s_waitcnt lgkmcnt(6)
    v_mfma_f32_32x32x16_bf16 v[64:79], v[40:43], v[56:59], v[64:79]
    s_add_u32 m0, s33, 100352
    s_add_u32 s35, s30, 20864
    buffer_load_dwordx4 v2, s[12:15], s35 offen lds
    v_mfma_f32_32x32x16_bf16 v[80:95], v[40:43], v[60:63], v[80:95]
    v_mfma_f32_32x32x16_bf16 v[96:111], v[44:47], v[56:59], v[96:111]
    s_add_u32 m0, s33, 101376
    s_add_u32 s35, s30, 31104
    buffer_load_dwordx4 v3, s[12:15], s35 offen lds
    v_mfma_f32_32x32x16_bf16 v[112:127], v[44:47], v[60:63], v[112:127]
    ds_read_b128 v[40:43], v11
    ds_read_b128 v[44:47], v11 offset:4096
    ds_read_b64_tr_b16 v[56:57], v16 offset:28672
    ds_read_b64_tr_b16 v[58:59], v16 offset:29696
    ds_read_b64_tr_b16 v[60:61], v17 offset:28672
    ds_read_b64_tr_b16 v[62:63], v17 offset:29696
    s_waitcnt lgkmcnt(6)
    v_mfma_f32_32x32x16_bf16 v[64:79], v[32:35], v[48:51], v[64:79]
    s_add_u32 m0, s34, 114688
    s_add_u32 s35, s31, 737280
    buffer_load_dwordx4 v4, s[16:19], s35 offen lds
    v_mfma_f32_32x32x16_bf16 v[80:95], v[32:35], v[52:55], v[80:95]
    v_mfma_f32_32x32x16_bf16 v[96:111], v[36:39], v[48:51], v[96:111]
    s_add_u32 m0, s34, 115712
    s_add_u32 s35, s31, 752640
    buffer_load_dwordx4 v4, s[16:19], s35 offen lds
    v_mfma_f32_32x32x16_bf16 v[112:127], v[36:39], v[52:55], v[112:127]
    s_waitcnt lgkmcnt(0)
    v_mfma_f32_32x32x16_bf16 v[64:79], v[40:43], v[56:59], v[64:79]
    s_add_u32 m0, s34, 116736
    s_add_u32 s35, s31, 768000
    buffer_load_dwordx4 v4, s[16:19], s35 offen lds
    v_mfma_f32_32x32x16_bf16 v[80:95], v[40:43], v[60:63], v[80:95]
    v_mfma_f32_32x32x16_bf16 v[96:111], v[44:47], v[56:59], v[96:111]
    s_add_u32 m0, s34, 117760
    s_add_u32 s35, s31, 783360
    buffer_load_dwordx4 v4, s[16:19], s35 offen lds
    v_mfma_f32_32x32x16_bf16 v[112:127], v[44:47], v[60:63], v[112:127]
    s_waitcnt vmcnt(16)
    s_barrier
    ds_read_b128 v[32:35], v8 offset:32768
    ds_read_b128 v[36:39], v8 offset:36864
    ds_read_b64_tr_b16 v[48:49], v16 offset:49152
    ds_read_b64_tr_b16 v[50:51], v16 offset:50176
    ds_read_b64_tr_b16 v[52:53], v17 offset:49152
    ds_read_b64_tr_b16 v[54:55], v17 offset:50176
    ds_read_b128 v[40:43], v9 offset:32768
    ds_read_b128 v[44:47], v9 offset:36864
    ds_read_b64_tr_b16 v[56:57], v16 offset:53248
    ds_read_b64_tr_b16 v[58:59], v16 offset:54272
    ds_read_b64_tr_b16 v[60:61], v17 offset:53248
    ds_read_b64_tr_b16 v[62:63], v17 offset:54272
    s_waitcnt lgkmcnt(6)
    v_mfma_f32_32x32x16_bf16 v[64:79], v[32:35], v[48:51], v[64:79]
    s_add_u32 m0, s33, 0
    s_add_u32 s35, s30, 512
    buffer_load_dwordx4 v2, s[12:15], s35 offen lds
    v_mfma_f32_32x32x16_bf16 v[80:95], v[32:35], v[52:55], v[80:95]
    v_mfma_f32_32x32x16_bf16 v[96:111], v[36:39], v[48:51], v[96:111]
    s_add_u32 m0, s33, 1024
    s_add_u32 s35, s30, 10752
    buffer_load_dwordx4 v3, s[12:15], s35 offen lds
    v_mfma_f32_32x32x16_bf16 v[112:127], v[36:39], v[52:55], v[112:127]
    ds_read_b128 v[32:35], v10 offset:32768
    ds_read_b128 v[36:39], v10 offset:36864
    ds_read_b64_tr_b16 v[48:49], v16 offset:57344
    ds_read_b64_tr_b16 v[50:51], v16 offset:58368
    ds_read_b64_tr_b16 v[52:53], v17 offset:57344
    ds_read_b64_tr_b16 v[54:55], v17 offset:58368
    s_waitcnt lgkmcnt(6)
    v_mfma_f32_32x32x16_bf16 v[64:79], v[40:43], v[56:59], v[64:79]
    s_add_u32 m0, s33, 2048
    s_add_u32 s35, s30, 20992
    buffer_load_dwordx4 v2, s[12:15], s35 offen lds
    v_mfma_f32_32x32x16_bf16 v[80:95], v[40:43], v[60:63], v[80:95]
    v_mfma_f32_32x32x16_bf16 v[96:111], v[44:47], v[56:59], v[96:111]
    s_add_u32 m0, s33, 3072
    s_add_u32 s35, s30, 31232
    buffer_load_dwordx4 v3, s[12:15], s35 offen lds
    v_mfma_f32_32x32x16_bf16 v[112:127], v[44:47], v[60:63], v[112:127]
    ds_read_b128 v[40:43], v11 offset:32768
    ds_read_b128 v[44:47], v11 offset:36864
    ds_read_b64_tr_b16 v[56:57], v16 offset:61440
    ds_read_b64_tr_b16 v[58:59], v16 offset:62464
    ds_read_b64_tr_b16 v[60:61], v17 offset:61440
    ds_read_b64_tr_b16 v[62:63], v17 offset:62464
    s_waitcnt lgkmcnt(6)
    v_mfma_f32_32x32x16_bf16 v[64:79], v[32:35], v[48:51], v[64:79]
    s_add_u32 m0, s34, 16384
    s_add_u32 s35, s31, 983040
    buffer_load_dwordx4 v4, s[16:19], s35 offen lds
    v_mfma_f32_32x32x16_bf16 v[80:95], v[32:35], v[52:55], v[80:95]
    v_mfma_f32_32x32x16_bf16 v[96:111], v[36:39], v[48:51], v[96:111]
    s_add_u32 m0, s34, 17408
    s_add_u32 s35, s31, 998400
    buffer_load_dwordx4 v4, s[16:19], s35 offen lds
    v_mfma_f32_32x32x16_bf16 v[112:127], v[36:39], v[52:55], v[112:127]
    s_waitcnt lgkmcnt(0)
    v_mfma_f32_32x32x16_bf16 v[64:79], v[40:43], v[56:59], v[64:79]
    s_add_u32 m0, s34, 18432
    s_add_u32 s35, s31, 1013760
    buffer_load_dwordx4 v4, s[16:19], s35 offen lds
    v_mfma_f32_32x32x16_bf16 v[80:95], v[40:43], v[60:63], v[80:95]
    v_mfma_f32_32x32x16_bf16 v[96:111], v[44:47], v[56:59], v[96:111]
    s_add_u32 m0, s34, 19456
    s_add_u32 s35, s31, 1029120
    buffer_load_dwordx4 v4, s[16:19], s35 offen lds
    v_mfma_f32_32x32x16_bf16 v[112:127], v[44:47], v[60:63], v[112:127]
    s_waitcnt vmcnt(16)
    s_barrier
    ds_read_b128 v[32:35], v12
    ds_read_b128 v[36:39], v12 offset:4096
    ds_read_b64_tr_b16 v[48:49], v18 offset:16384
    ds_read_b64_tr_b16 v[50:51], v18 offset:17408
    ds_read_b64_tr_b16 v[52:53], v19 offset:16384
    ds_read_b64_tr_b16 v[54:55], v19 offset:17408
    ds_read_b128 v[40:43], v13
    ds_read_b128 v[44:47], v13 offset:4096
    ds_read_b64_tr_b16 v[56:57], v18 offset:20480
    ds_read_b64_tr_b16 v[58:59], v18 offset:21504
    ds_read_b64_tr_b16 v[60:61], v19 offset:20480
    ds_read_b64_tr_b16 v[62:63], v19 offset:21504
    s_waitcnt lgkmcnt(6)
    v_mfma_f32_32x32x16_bf16 v[64:79], v[32:35], v[48:51], v[64:79]
    s_add_u32 m0, s33, 32768
    s_add_u32 s35, s30, 640
    buffer_load_dwordx4 v2, s[12:15], s35 offen lds
    v_mfma_f32_32x32x16_bf16 v[80:95], v[32:35], v[52:55], v[80:95]
    v_mfma_f32_32x32x16_bf16 v[96:111], v[36:39], v[48:51], v[96:111]
    s_add_u32 m0, s33, 33792
    s_add_u32 s35, s30, 10880
    buffer_load_dwordx4 v3, s[12:15], s35 offen lds
    v_mfma_f32_32x32x16_bf16 v[112:127], v[36:39], v[52:55], v[112:127]
    ds_read_b128 v[32:35], v14
    ds_read_b128 v[36:39], v14 offset:4096
    ds_read_b64_tr_b16 v[48:49], v18 offset:24576
    ds_read_b64_tr_b16 v[50:51], v18 offset:25600
    ds_read_b64_tr_b16 v[52:53], v19 offset:24576
    ds_read_b64_tr_b16 v[54:55], v19 offset:25600
    s_waitcnt lgkmcnt(6)
    v_mfma_f32_32x32x16_bf16 v[64:79], v[40:43], v[56:59], v[64:79]
    s_add_u32 m0, s33, 34816
    s_add_u32 s35, s30, 21120
    buffer_load_dwordx4 v2, s[12:15], s35 offen lds
    v_mfma_f32_32x32x16_bf16 v[80:95], v[40:43], v[60:63], v[80:95]
    v_mfma_f32_32x32x16_bf16 v[96:111], v[44:47], v[56:59], v[96:111]
    s_add_u32 m0, s33, 35840
    s_add_u32 s35, s30, 31360
    buffer_load_dwordx4 v3, s[12:15], s35 offen lds
    v_mfma_f32_32x32x16_bf16 v[112:127], v[44:47], v[60:63], v[112:127]
    ds_read_b128 v[40:43], v15
    ds_read_b128 v[44:47], v15 offset:4096
    ds_read_b64_tr_b16 v[56:57], v18 offset:28672
    ds_read_b64_tr_b16 v[58:59], v18 offset:29696
    ds_read_b64_tr_b16 v[60:61], v19 offset:28672
    ds_read_b64_tr_b16 v[62:63], v19 offset:29696
    s_waitcnt lgkmcnt(6)
    v_mfma_f32_32x32x16_bf16 v[64:79], v[32:35], v[48:51], v[64:79]
    s_add_u32 m0, s34, 49152
    s_add_u32 s35, s31, 1228800
    buffer_load_dwordx4 v4, s[16:19], s35 offen lds
    v_mfma_f32_32x32x16_bf16 v[80:95], v[32:35], v[52:55], v[80:95]
    v_mfma_f32_32x32x16_bf16 v[96:111], v[36:39], v[48:51], v[96:111]
    s_add_u32 m0, s34, 50176
    s_add_u32 s35, s31, 1244160
    buffer_load_dwordx4 v4, s[16:19], s35 offen lds
    v_mfma_f32_32x32x16_bf16 v[112:127], v[36:39], v[52:55], v[112:127]
    s_waitcnt lgkmcnt(0)
    v_mfma_f32_32x32x16_bf16 v[64:79], v[40:43], v[56:59], v[64:79]
    s_add_u32 m0, s34, 51200
    s_add_u32 s35, s31, 1259520
    buffer_load_dwordx4 v4, s[16:19], s35 offen lds
    v_mfma_f32_32x32x16_bf16 v[80:95], v[40:43], v[60:63], v[80:95]
    v_mfma_f32_32x32x16_bf16 v[96:111], v[44:47], v[56:59], v[96:111]
    s_add_u32 m0, s34, 52224
    s_add_u32 s35, s31, 1274880
    buffer_load_dwordx4 v4, s[16:19], s35 offen lds
    v_mfma_f32_32x32x16_bf16 v[112:127], v[44:47], v[60:63], v[112:127]
    s_waitcnt vmcnt(16)
    s_barrier
    ds_read_b128 v[32:35], v12 offset:32768
    ds_read_b128 v[36:39], v12 offset:36864
    ds_read_b64_tr_b16 v[48:49], v18 offset:49152
    ds_read_b64_tr_b16 v[50:51], v18 offset:50176
    ds_read_b64_tr_b16 v[52:53], v19 offset:49152
    ds_read_b64_tr_b16 v[54:55], v19 offset:50176
    ds_read_b128 v[40:43], v13 offset:32768
    ds_read_b128 v[44:47], v13 offset:36864
    ds_read_b64_tr_b16 v[56:57], v18 offset:53248
    ds_read_b64_tr_b16 v[58:59], v18 offset:54272
    ds_read_b64_tr_b16 v[60:61], v19 offset:53248
    ds_read_b64_tr_b16 v[62:63], v19 offset:54272
    s_waitcnt lgkmcnt(6)
    v_mfma_f32_32x32x16_bf16 v[64:79], v[32:35], v[48:51], v[64:79]
    s_add_u32 m0, s33, 65536
    s_add_u32 s35, s30, 768
    buffer_load_dwordx4 v2, s[12:15], s35 offen lds
    v_mfma_f32_32x32x16_bf16 v[80:95], v[32:35], v[52:55], v[80:95]
    v_mfma_f32_32x32x16_bf16 v[96:111], v[36:39], v[48:51], v[96:111]
    s_add_u32 m0, s33, 66560
    s_add_u32 s35, s30, 11008
    buffer_load_dwordx4 v3, s[12:15], s35 offen lds
    v_mfma_f32_32x32x16_bf16 v[112:127], v[36:39], v[52:55], v[112:127]
    ds_read_b128 v[32:35], v14 offset:32768
    ds_read_b128 v[36:39], v14 offset:36864
    ds_read_b64_tr_b16 v[48:49], v18 offset:57344
    ds_read_b64_tr_b16 v[50:51], v18 offset:58368
    ds_read_b64_tr_b16 v[52:53], v19 offset:57344
    ds_read_b64_tr_b16 v[54:55], v19 offset:58368
    s_waitcnt lgkmcnt(6)
    v_mfma_f32_32x32x16_bf16 v[64:79], v[40:43], v[56:59], v[64:79]
    s_add_u32 m0, s33, 67584
    s_add_u32 s35, s30, 21248
    buffer_load_dwordx4 v2, s[12:15], s35 offen lds
    v_mfma_f32_32x32x16_bf16 v[80:95], v[40:43], v[60:63], v[80:95]
    v_mfma_f32_32x32x16_bf16 v[96:111], v[44:47], v[56:59], v[96:111]
    s_add_u32 m0, s33, 68608
    s_add_u32 s35, s30, 31488
    buffer_load_dwordx4 v3, s[12:15], s35 offen lds
    v_mfma_f32_32x32x16_bf16 v[112:127], v[44:47], v[60:63], v[112:127]
    ds_read_b128 v[40:43], v15 offset:32768
    ds_read_b128 v[44:47], v15 offset:36864
    ds_read_b64_tr_b16 v[56:57], v18 offset:61440
    ds_read_b64_tr_b16 v[58:59], v18 offset:62464
    ds_read_b64_tr_b16 v[60:61], v19 offset:61440
    ds_read_b64_tr_b16 v[62:63], v19 offset:62464
    s_waitcnt lgkmcnt(6)
    v_mfma_f32_32x32x16_bf16 v[64:79], v[32:35], v[48:51], v[64:79]
    s_add_u32 m0, s34, 81920
    s_add_u32 s35, s31, 1474560
    buffer_load_dwordx4 v4, s[16:19], s35 offen lds
    v_mfma_f32_32x32x16_bf16 v[80:95], v[32:35], v[52:55], v[80:95]
    v_mfma_f32_32x32x16_bf16 v[96:111], v[36:39], v[48:51], v[96:111]
    s_add_u32 m0, s34, 82944
    s_add_u32 s35, s31, 1489920
    buffer_load_dwordx4 v4, s[16:19], s35 offen lds
    v_mfma_f32_32x32x16_bf16 v[112:127], v[36:39], v[52:55], v[112:127]
    s_waitcnt lgkmcnt(0)
    v_mfma_f32_32x32x16_bf16 v[64:79], v[40:43], v[56:59], v[64:79]
    s_add_u32 m0, s34, 83968
    s_add_u32 s35, s31, 1505280
    buffer_load_dwordx4 v4, s[16:19], s35 offen lds
    v_mfma_f32_32x32x16_bf16 v[80:95], v[40:43], v[60:63], v[80:95]
    v_mfma_f32_32x32x16_bf16 v[96:111], v[44:47], v[56:59], v[96:111]
    s_add_u32 m0, s34, 84992
    s_add_u32 s35, s31, 1520640
    buffer_load_dwordx4 v4, s[16:19], s35 offen lds
    v_mfma_f32_32x32x16_bf16 v[112:127], v[44:47], v[60:63], v[112:127]
    s_waitcnt vmcnt(16)
    s_barrier
    ds_read_b128 v[32:35], v8
    ds_read_b128 v[36:39], v8 offset:4096
    ds_read_b64_tr_b16 v[48:49], v16 offset:16384
    ds_read_b64_tr_b16 v[50:51], v16 offset:17408
    ds_read_b64_tr_b16 v[52:53], v17 offset:16384
    ds_read_b64_tr_b16 v[54:55], v17 offset:17408
    ds_read_b128 v[40:43], v9
    ds_read_b128 v[44:47], v9 offset:4096
    ds_read_b64_tr_b16 v[56:57], v16 offset:20480
    ds_read_b64_tr_b16 v[58:59], v16 offset:21504
    ds_read_b64_tr_b16 v[60:61], v17 offset:20480
    ds_read_b64_tr_b16 v[62:63], v17 offset:21504
    s_waitcnt lgkmcnt(6)
    v_mfma_f32_32x32x16_bf16 v[64:79], v[32:35], v[48:51], v[64:79]
    s_add_u32 m0, s33, 98304
    s_add_u32 s35, s30, 896
    buffer_load_dwordx4 v2, s[12:15], s35 offen lds
    v_mfma_f32_32x32x16_bf16 v[80:95], v[32:35], v[52:55], v[80:95]
    v_mfma_f32_32x32x16_bf16 v[96:111], v[36:39], v[48:51], v[96:111]
    s_add_u32 m0, s33, 99328
    s_add_u32 s35, s30, 11136
    buffer_load_dwordx4 v3, s[12:15], s35 offen lds
    v_mfma_f32_32x32x16_bf16 v[112:127], v[36:39], v[52:55], v[112:127]
    ds_read_b128 v[32:35], v10
    ds_read_b128 v[36:39], v10 offset:4096
    ds_read_b64_tr_b16 v[48:49], v16 offset:24576
    ds_read_b64_tr_b16 v[50:51], v16 offset:25600
    ds_read_b64_tr_b16 v[52:53], v17 offset:24576
    ds_read_b64_tr_b16 v[54:55], v17 offset:25600
    s_waitcnt lgkmcnt(6)
    v_mfma_f32_32x32x16_bf16 v[64:79], v[40:43], v[56:59], v[64:79]
    s_add_u32 m0, s33, 100352
    s_add_u32 s35, s30, 21376
    buffer_load_dwordx4 v2, s[12:15], s35 offen lds
    v_mfma_f32_32x32x16_bf16 v[80:95], v[40:43], v[60:63], v[80:95]
    v_mfma_f32_32x32x16_bf16 v[96:111], v[44:47], v[56:59], v[96:111]
    s_add_u32 m0, s33, 101376
    s_add_u32 s35, s30, 31616
    buffer_load_dwordx4 v3, s[12:15], s35 offen lds
    v_mfma_f32_32x32x16_bf16 v[112:127], v[44:47], v[60:63], v[112:127]
    ds_read_b128 v[40:43], v11
    ds_read_b128 v[44:47], v11 offset:4096
    ds_read_b64_tr_b16 v[56:57], v16 offset:28672
    ds_read_b64_tr_b16 v[58:59], v16 offset:29696
    ds_read_b64_tr_b16 v[60:61], v17 offset:28672
    ds_read_b64_tr_b16 v[62:63], v17 offset:29696
    s_waitcnt lgkmcnt(6)
    v_mfma_f32_32x32x16_bf16 v[64:79], v[32:35], v[48:51], v[64:79]
    s_add_u32 m0, s34, 114688
    s_add_u32 s35, s31, 1720320
    buffer_load_dwordx4 v4, s[16:19], s35 offen lds
    v_mfma_f32_32x32x16_bf16 v[80:95], v[32:35], v[52:55], v[80:95]
    v_mfma_f32_32x32x16_bf16 v[96:111], v[36:39], v[48:51], v[96:111]
    s_add_u32 m0, s34, 115712
    s_add_u32 s35, s31, 1735680
    buffer_load_dwordx4 v4, s[16:19], s35 offen lds
    v_mfma_f32_32x32x16_bf16 v[112:127], v[36:39], v[52:55], v[112:127]
    s_waitcnt lgkmcnt(0)
    v_mfma_f32_32x32x16_bf16 v[64:79], v[40:43], v[56:59], v[64:79]
    s_add_u32 m0, s34, 116736
    s_add_u32 s35, s31, 1751040
    buffer_load_dwordx4 v4, s[16:19], s35 offen lds
    v_mfma_f32_32x32x16_bf16 v[80:95], v[40:43], v[60:63], v[80:95]
    v_mfma_f32_32x32x16_bf16 v[96:111], v[44:47], v[56:59], v[96:111]
    s_add_u32 m0, s34, 117760
    s_add_u32 s35, s31, 1766400
    buffer_load_dwordx4 v4, s[16:19], s35 offen lds
    v_mfma_f32_32x32x16_bf16 v[112:127], v[44:47], v[60:63], v[112:127]
    s_waitcnt vmcnt(16)
    s_barrier
    ds_read_b128 v[32:35], v8 offset:32768
    ds_read_b128 v[36:39], v8 offset:36864
    ds_read_b64_tr_b16 v[48:49], v16 offset:49152
    ds_read_b64_tr_b16 v[50:51], v16 offset:50176
    ds_read_b64_tr_b16 v[52:53], v17 offset:49152
    ds_read_b64_tr_b16 v[54:55], v17 offset:50176
    ds_read_b128 v[40:43], v9 offset:32768
    ds_read_b128 v[44:47], v9 offset:36864
    ds_read_b64_tr_b16 v[56:57], v16 offset:53248
    ds_read_b64_tr_b16 v[58:59], v16 offset:54272
    ds_read_b64_tr_b16 v[60:61], v17 offset:53248
    ds_read_b64_tr_b16 v[62:63], v17 offset:54272
    s_waitcnt lgkmcnt(6)
    v_mfma_f32_32x32x16_bf16 v[64:79], v[32:35], v[48:51], v[64:79]
    s_add_u32 m0, s33, 0
    s_add_u32 s35, s30, 1024
    buffer_load_dwordx4 v2, s[12:15], s35 offen lds
    v_mfma_f32_32x32x16_bf16 v[80:95], v[32:35], v[52:55], v[80:95]
    v_mfma_f32_32x32x16_bf16 v[96:111], v[36:39], v[48:51], v[96:111]
    s_add_u32 m0, s33, 1024
    s_add_u32 s35, s30, 11264
    buffer_load_dwordx4 v3, s[12:15], s35 offen lds
    v_mfma_f32_32x32x16_bf16 v[112:127], v[36:39], v[52:55], v[112:127]
    ds_read_b128 v[32:35], v10 offset:32768
    ds_read_b128 v[36:39], v10 offset:36864
    ds_read_b64_tr_b16 v[48:49], v16 offset:57344
    ds_read_b64_tr_b16 v[50:51], v16 offset:58368
    ds_read_b64_tr_b16 v[52:53], v17 offset:57344
    ds_read_b64_tr_b16 v[54:55], v17 offset:58368
    s_waitcnt lgkmcnt(6)
    v_mfma_f32_32x32x16_bf16 v[64:79], v[40:43], v[56:59], v[64:79]
    s_add_u32 m0, s33, 2048
    s_add_u32 s35, s30, 21504
    buffer_load_dwordx4 v2, s[12:15], s35 offen lds
    v_mfma_f32_32x32x16_bf16 v[80:95], v[40:43], v[60:63], v[80:95]
    v_mfma_f32_32x32x16_bf16 v[96:111], v[44:47], v[56:59], v[96:111]
    s_add_u32 m0, s33, 3072
    s_add_u32 s35, s30, 31744
    buffer_load_dwordx4 v3, s[12:15], s35 offen lds
    v_mfma_f32_32x32x16_bf16 v[112:127], v[44:47], v[60:63], v[112:127]
    ds_read_b128 v[40:43], v11 offset:32768
    ds_read_b128 v[44:47], v11 offset:36864
    ds_read_b64_tr_b16 v[56:57], v16 offset:61440
    ds_read_b64_tr_b16 v[58:59], v16 offset:62464
    ds_read_b64_tr_b16 v[60:61], v17 offset:61440
    ds_read_b64_tr_b16 v[62:63], v17 offset:62464
    s_waitcnt lgkmcnt(6)
    v_mfma_f32_32x32x16_bf16 v[64:79], v[32:35], v[48:51], v[64:79]
    s_add_u32 m0, s34, 16384
    s_add_u32 s35, s31, 1966080
    buffer_load_dwordx4 v4, s[16:19], s35 offen lds
    v_mfma_f32_32x32x16_bf16 v[80:95], v[32:35], v[52:55], v[80:95]
    v_mfma_f32_32x32x16_bf16 v[96:111], v[36:39], v[48:51], v[96:111]
    s_add_u32 m0, s34, 17408
    s_add_u32 s35, s31, 1981440
    buffer_load_dwordx4 v4, s[16:19], s35 offen lds
    v_mfma_f32_32x32x16_bf16 v[112:127], v[36:39], v[52:55], v[112:127]
    s_waitcnt lgkmcnt(0)
    v_mfma_f32_32x32x16_bf16 v[64:79], v[40:43], v[56:59], v[64:79]
    s_add_u32 m0, s34, 18432
    s_add_u32 s35, s31, 1996800
    buffer_load_dwordx4 v4, s[16:19], s35 offen lds
    v_mfma_f32_32x32x16_bf16 v[80:95], v[40:43], v[60:63], v[80:95]
    v_mfma_f32_32x32x16_bf16 v[96:111], v[44:47], v[56:59], v[96:111]
    s_add_u32 m0, s34, 19456
    s_add_u32 s35, s31, 2012160
    buffer_load_dwordx4 v4, s[16:19], s35 offen lds
    v_mfma_f32_32x32x16_bf16 v[112:127], v[44:47], v[60:63], v[112:127]
    s_waitcnt vmcnt(16)
    s_barrier
    ds_read_b128 v[32:35], v12
    ds_read_b128 v[36:39], v12 offset:4096
    ds_read_b64_tr_b16 v[48:49], v18 offset:16384
    ds_read_b64_tr_b16 v[50:51], v18 offset:17408
    ds_read_b64_tr_b16 v[52:53], v19 offset:16384
    ds_read_b64_tr_b16 v[54:55], v19 offset:17408
    ds_read_b128 v[40:43], v13
    ds_read_b128 v[44:47], v13 offset:4096
    ds_read_b64_tr_b16 v[56:57], v18 offset:20480
    ds_read_b64_tr_b16 v[58:59], v18 offset:21504
    ds_read_b64_tr_b16 v[60:61], v19 offset:20480
    ds_read_b64_tr_b16 v[62:63], v19 offset:21504
    s_waitcnt lgkmcnt(6)
    v_mfma_f32_32x32x16_bf16 v[64:79], v[32:35], v[48:51], v[64:79]
    s_add_u32 m0, s33, 32768
    s_add_u32 s35, s30, 1152
    buffer_load_dwordx4 v2, s[12:15], s35 offen lds
    v_mfma_f32_32x32x16_bf16 v[80:95], v[32:35], v[52:55], v[80:95]
    v_mfma_f32_32x32x16_bf16 v[96:111], v[36:39], v[48:51], v[96:111]
    s_add_u32 m0, s33, 33792
    s_add_u32 s35, s30, 11392
    buffer_load_dwordx4 v3, s[12:15], s35 offen lds
    v_mfma_f32_32x32x16_bf16 v[112:127], v[36:39], v[52:55], v[112:127]
    ds_read_b128 v[32:35], v14
    ds_read_b128 v[36:39], v14 offset:4096
    ds_read_b64_tr_b16 v[48:49], v18 offset:24576
    ds_read_b64_tr_b16 v[50:51], v18 offset:25600
    ds_read_b64_tr_b16 v[52:53], v19 offset:24576
    ds_read_b64_tr_b16 v[54:55], v19 offset:25600
    s_waitcnt lgkmcnt(6)
    v_mfma_f32_32x32x16_bf16 v[64:79], v[40:43], v[56:59], v[64:79]
    s_add_u32 m0, s33, 34816
    s_add_u32 s35, s30, 21632
    buffer_load_dwordx4 v2, s[12:15], s35 offen lds
    v_mfma_f32_32x32x16_bf16 v[80:95], v[40:43], v[60:63], v[80:95]
    v_mfma_f32_32x32x16_bf16 v[96:111], v[44:47], v[56:59], v[96:111]
    s_add_u32 m0, s33, 35840
    s_add_u32 s35, s30, 31872
    buffer_load_dwordx4 v3, s[12:15], s35 offen lds
    v_mfma_f32_32x32x16_bf16 v[112:127], v[44:47], v[60:63], v[112:127]
    ds_read_b128 v[40:43], v15
    ds_read_b128 v[44:47], v15 offset:4096
    ds_read_b64_tr_b16 v[56:57], v18 offset:28672
    ds_read_b64_tr_b16 v[58:59], v18 offset:29696
    ds_read_b64_tr_b16 v[60:61], v19 offset:28672
    ds_read_b64_tr_b16 v[62:63], v19 offset:29696
    s_waitcnt lgkmcnt(6)
    v_mfma_f32_32x32x16_bf16 v[64:79], v[32:35], v[48:51], v[64:79]
    s_add_u32 m0, s34, 49152
    s_add_u32 s35, s31, 2211840
    buffer_load_dwordx4 v4, s[16:19], s35 offen lds
    v_mfma_f32_32x32x16_bf16 v[80:95], v[32:35], v[52:55], v[80:95]
    v_mfma_f32_32x32x16_bf16 v[96:111], v[36:39], v[48:51], v[96:111]
    s_add_u32 m0, s34, 50176
    s_add_u32 s35, s31, 2227200
    buffer_load_dwordx4 v4, s[16:19], s35 offen lds
    v_mfma_f32_32x32x16_bf16 v[112:127], v[36:39], v[52:55], v[112:127]
    s_waitcnt lgkmcnt(0)
    v_mfma_f32_32x32x16_bf16 v[64:79], v[40:43], v[56:59], v[64:79]
    s_add_u32 m0, s34, 51200
    s_add_u32 s35, s31, 2242560
    buffer_load_dwordx4 v4, s[16:19], s35 offen lds
    v_mfma_f32_32x32x16_bf16 v[80:95], v[40:43], v[60:63], v[80:95]
    v_mfma_f32_32x32x16_bf16 v[96:111], v[44:47], v[56:59], v[96:111]
    s_add_u32 m0, s34, 52224
    s_add_u32 s35, s31, 2257920
    buffer_load_dwordx4 v4, s[16:19], s35 offen lds
    v_mfma_f32_32x32x16_bf16 v[112:127], v[44:47], v[60:63], v[112:127]
    s_waitcnt vmcnt(16)
    s_barrier
    ds_read_b128 v[32:35], v12 offset:32768
    ds_read_b128 v[36:39], v12 offset:36864
    ds_read_b64_tr_b16 v[48:49], v18 offset:49152
    ds_read_b64_tr_b16 v[50:51], v18 offset:50176
    ds_read_b64_tr_b16 v[52:53], v19 offset:49152
    ds_read_b64_tr_b16 v[54:55], v19 offset:50176
    ds_read_b128 v[40:43], v13 offset:32768
    ds_read_b128 v[44:47], v13 offset:36864
    ds_read_b64_tr_b16 v[56:57], v18 offset:53248
    ds_read_b64_tr_b16 v[58:59], v18 offset:54272
    ds_read_b64_tr_b16 v[60:61], v19 offset:53248
    ds_read_b64_tr_b16 v[62:63], v19 offset:54272
    s_waitcnt lgkmcnt(6)
    v_mfma_f32_32x32x16_bf16 v[64:79], v[32:35], v[48:51], v[64:79]
    v_mfma_f32_32x32x16_bf16 v[80:95], v[32:35], v[52:55], v[80:95]
    v_mfma_f32_32x32x16_bf16 v[96:111], v[36:39], v[48:51], v[96:111]
    v_mfma_f32_32x32x16_bf16 v[112:127], v[36:39], v[52:55], v[112:127]
    ds_read_b128 v[32:35], v14 offset:32768
    ds_read_b128 v[36:39], v14 offset:36864
    ds_read_b64_tr_b16 v[48:49], v18 offset:57344
    ds_read_b64_tr_b16 v[50:51], v18 offset:58368
    ds_read_b64_tr_b16 v[52:53], v19 offset:57344
    ds_read_b64_tr_b16 v[54:55], v19 offset:58368
    s_waitcnt lgkmcnt(6)
    v_mfma_f32_32x32x16_bf16 v[64:79], v[40:43], v[56:59], v[64:79]
    v_mfma_f32_32x32x16_bf16 v[80:95], v[40:43], v[60:63], v[80:95]
    v_mfma_f32_32x32x16_bf16 v[96:111], v[44:47], v[56:59], v[96:111]
    v_mfma_f32_32x32x16_bf16 v[112:127], v[44:47], v[60:63], v[112:127]
    ds_read_b128 v[40:43], v15 offset:32768
    ds_read_b128 v[44:47], v15 offset:36864
    ds_read_b64_tr_b16 v[56:57], v18 offset:61440
    ds_read_b64_tr_b16 v[58:59], v18 offset:62464
    ds_read_b64_tr_b16 v[60:61], v19 offset:61440
    ds_read_b64_tr_b16 v[62:63], v19 offset:62464
    s_waitcnt lgkmcnt(6)
    v_mfma_f32_32x32x16_bf16 v[64:79], v[32:35], v[48:51], v[64:79]
    v_mfma_f32_32x32x16_bf16 v[80:95], v[32:35], v[52:55], v[80:95]
    v_mfma_f32_32x32x16_bf16 v[96:111], v[36:39], v[48:51], v[96:111]
    v_mfma_f32_32x32x16_bf16 v[112:127], v[36:39], v[52:55], v[112:127]
    s_waitcnt lgkmcnt(0)
    v_mfma_f32_32x32x16_bf16 v[64:79], v[40:43], v[56:59], v[64:79]
    v_mfma_f32_32x32x16_bf16 v[80:95], v[40:43], v[60:63], v[80:95]
    v_mfma_f32_32x32x16_bf16 v[96:111], v[44:47], v[56:59], v[96:111]
    v_mfma_f32_32x32x16_bf16 v[112:127], v[44:47], v[60:63], v[112:127]
    s_waitcnt vmcnt(8)
    s_barrier
    ds_read_b128 v[32:35], v8
    ds_read_b128 v[36:39], v8 offset:4096
    ds_read_b64_tr_b16 v[48:49], v16 offset:16384
    ds_read_b64_tr_b16 v[50:51], v16 offset:17408
    ds_read_b64_tr_b16 v[52:53], v17 offset:16384
    ds_read_b64_tr_b16 v[54:55], v17 offset:17408
    ds_read_b128 v[40:43], v9
    ds_read_b128 v[44:47], v9 offset:4096
    ds_read_b64_tr_b16 v[56:57], v16 offset:20480
    ds_read_b64_tr_b16 v[58:59], v16 offset:21504
    ds_read_b64_tr_b16 v[60:61], v17 offset:20480
    ds_read_b64_tr_b16 v[62:63], v17 offset:21504
    s_waitcnt lgkmcnt(6)
    v_mfma_f32_32x32x16_bf16 v[64:79], v[32:35], v[48:51], v[64:79]
    v_mfma_f32_32x32x16_bf16 v[80:95], v[32:35], v[52:55], v[80:95]
    v_mfma_f32_32x32x16_bf16 v[96:111], v[36:39], v[48:51], v[96:111]
    v_mfma_f32_32x32x16_bf16 v[112:127], v[36:39], v[52:55], v[112:127]
    ds_read_b128 v[32:35], v10
    ds_read_b128 v[36:39], v10 offset:4096
    ds_read_b64_tr_b16 v[48:49], v16 offset:24576
    ds_read_b64_tr_b16 v[50:51], v16 offset:25600
    ds_read_b64_tr_b16 v[52:53], v17 offset:24576
    ds_read_b64_tr_b16 v[54:55], v17 offset:25600
    s_waitcnt lgkmcnt(6)
    v_mfma_f32_32x32x16_bf16 v[64:79], v[40:43], v[56:59], v[64:79]
    v_mfma_f32_32x32x16_bf16 v[80:95], v[40:43], v[60:63], v[80:95]
    v_mfma_f32_32x32x16_bf16 v[96:111], v[44:47], v[56:59], v[96:111]
    v_mfma_f32_32x32x16_bf16 v[112:127], v[44:47], v[60:63], v[112:127]
    ds_read_b128 v[40:43], v11
    ds_read_b128 v[44:47], v11 offset:4096
    ds_read_b64_tr_b16 v[56:57], v16 offset:28672
    ds_read_b64_tr_b16 v[58:59], v16 offset:29696
    ds_read_b64_tr_b16 v[60:61], v17 offset:28672
    ds_read_b64_tr_b16 v[62:63], v17 offset:29696
    s_waitcnt lgkmcnt(6)
    v_mfma_f32_32x32x16_bf16 v[64:79], v[32:35], v[48:51], v[64:79]
    v_mfma_f32_32x32x16_bf16 v[80:95], v[32:35], v[52:55], v[80:95]
    v_mfma_f32_32x32x16_bf16 v[96:111], v[36:39], v[48:51], v[96:111]
    v_mfma_f32_32x32x16_bf16 v[112:127], v[36:39], v[52:55], v[112:127]
    s_waitcnt lgkmcnt(0)
    v_mfma_f32_32x32x16_bf16 v[64:79], v[40:43], v[56:59], v[64:79]
    v_mfma_f32_32x32x16_bf16 v[80:95], v[40:43], v[60:63], v[80:95]
    v_mfma_f32_32x32x16_bf16 v[96:111], v[44:47], v[56:59], v[96:111]
    v_mfma_f32_32x32x16_bf16 v[112:127], v[44:47], v[60:63], v[112:127]
    s_waitcnt vmcnt(0)
    s_barrier
    ds_read_b128 v[32:35], v8 offset:32768
    ds_read_b128 v[36:39], v8 offset:36864
    ds_read_b64_tr_b16 v[48:49], v16 offset:49152
    ds_read_b64_tr_b16 v[50:51], v16 offset:50176
    ds_read_b64_tr_b16 v[52:53], v17 offset:49152
    ds_read_b64_tr_b16 v[54:55], v17 offset:50176
    ds_read_b128 v[40:43], v9 offset:32768
    ds_read_b128 v[44:47], v9 offset:36864
    ds_read_b64_tr_b16 v[56:57], v16 offset:53248
    ds_read_b64_tr_b16 v[58:59], v16 offset:54272
    ds_read_b64_tr_b16 v[60:61], v17 offset:53248
    ds_read_b64_tr_b16 v[62:63], v17 offset:54272
    s_waitcnt lgkmcnt(6)
    v_mfma_f32_32x32x16_bf16 v[64:79], v[32:35], v[48:51], v[64:79]
    v_mfma_f32_32x32x16_bf16 v[80:95], v[32:35], v[52:55], v[80:95]
    v_mfma_f32_32x32x16_bf16 v[96:111], v[36:39], v[48:51], v[96:111]
    v_mfma_f32_32x32x16_bf16 v[112:127], v[36:39], v[52:55], v[112:127]
    ds_read_b128 v[32:35], v10 offset:32768
    ds_read_b128 v[36:39], v10 offset:36864
    ds_read_b64_tr_b16 v[48:49], v16 offset:57344
    ds_read_b64_tr_b16 v[50:51], v16 offset:58368
    ds_read_b64_tr_b16 v[52:53], v17 offset:57344
    ds_read_b64_tr_b16 v[54:55], v17 offset:58368
    s_waitcnt lgkmcnt(6)
    v_mfma_f32_32x32x16_bf16 v[64:79], v[40:43], v[56:59], v[64:79]
    v_mfma_f32_32x32x16_bf16 v[80:95], v[40:43], v[60:63], v[80:95]
    v_mfma_f32_32x32x16_bf16 v[96:111], v[44:47], v[56:59], v[96:111]
    v_mfma_f32_32x32x16_bf16 v[112:127], v[44:47], v[60:63], v[112:127]
    ds_read_b128 v[40:43], v11 offset:32768
    ds_read_b128 v[44:47], v11 offset:36864
    ds_read_b64_tr_b16 v[56:57], v16 offset:61440
    ds_read_b64_tr_b16 v[58:59], v16 offset:62464
    ds_read_b64_tr_b16 v[60:61], v17 offset:61440
    ds_read_b64_tr_b16 v[62:63], v17 offset:62464
    s_waitcnt lgkmcnt(6)
    v_mfma_f32_32x32x16_bf16 v[64:79], v[32:35], v[48:51], v[64:79]
    v_mfma_f32_32x32x16_bf16 v[80:95], v[32:35], v[52:55], v[80:95]
    v_mfma_f32_32x32x16_bf16 v[96:111], v[36:39], v[48:51], v[96:111]
    v_mfma_f32_32x32x16_bf16 v[112:127], v[36:39], v[52:55], v[112:127]
    s_waitcnt lgkmcnt(0)
    v_mfma_f32_32x32x16_bf16 v[64:79], v[40:43], v[56:59], v[64:79]
    v_mfma_f32_32x32x16_bf16 v[80:95], v[40:43], v[60:63], v[80:95]
    v_mfma_f32_32x32x16_bf16 v[96:111], v[44:47], v[56:59], v[96:111]
    v_mfma_f32_32x32x16_bf16 v[112:127], v[44:47], v[60:63], v[112:127]
    s_nop 15
    s_nop 15
    s_barrier
    s_lshl_b32 s51, s25, 7
    s_sub_u32 s51, s51, 1280
    s_mul_i32 s50, s51, 52429
    s_lshr_b32 s50, s50, 20
    s_mul_i32 s52, s50, 20
    s_sub_u32 s51, s51, s52
    s_and_b32 s36, s20, 1
    s_lshl_b32 s36, s36, 6
    s_add_u32 s36, s36, s51
    v_and_b32 v20, 31, v1
    v_add_u32 v20, s36, v20
    v_lshrrev_b32 v21, 5, v1
    v_mul_u32_u24 v21, 320, v21
    s_lshr_b32 s36, s20, 1
    s_mul_i32 s36, s36, 2560
    v_add_u32 v21, s36, v21
    v_add_u32 v24, 0, v20
    v_mul_u32_u24 v25, 52429, v24
    v_lshrrev_b32 v25, 20, v25
    v_mul_u32_u24 v27, 20, v25
    v_sub_u32 v26, v24, v27
    v_mul_u32_u24 v25, 5120, v25
    v_lshl_add_u32 v25, v26, 4, v25
    v_add_u32 v22, v25, v21
    v_add_u32 v24, 32, v20
    v_mul_u32_u24 v25, 52429, v24
    v_lshrrev_b32 v25, 20, v25
    v_mul_u32_u24 v27, 20, v25
    v_sub_u32 v26, v24, v27
    v_mul_u32_u24 v25, 5120, v25
    v_lshl_add_u32 v25, v26, 4, v25
    v_add_u32 v23, v25, v21
    v_cvt_pk_bf16_f32 v64, v64, v65
    v_cvt_pk_bf16_f32 v65, v66, v67
    ds_write_b64 v22, v[64:65]
    v_cvt_pk_bf16_f32 v68, v68, v69
    v_cvt_pk_bf16_f32 v69, v70, v71
    ds_write_b64 v22, v[68:69] offset:8
    v_cvt_pk_bf16_f32 v72, v72, v73
    v_cvt_pk_bf16_f32 v73, v74, v75
    ds_write_b64 v22, v[72:73] offset:640
    v_cvt_pk_bf16_f32 v76, v76, v77
    v_cvt_pk_bf16_f32 v77, v78, v79
    ds_write_b64 v22, v[76:77] offset:648
    v_cvt_pk_bf16_f32 v80, v80, v81
    v_cvt_pk_bf16_f32 v81, v82, v83
    ds_write_b64 v23, v[80:81]
    v_cvt_pk_bf16_f32 v84, v84, v85
    v_cvt_pk_bf16_f32 v85, v86, v87
    ds_write_b64 v23, v[84:85] offset:8
    v_cvt_pk_bf16_f32 v88, v88, v89
    v_cvt_pk_bf16_f32 v89, v90, v91
    ds_write_b64 v23, v[88:89] offset:640
    v_cvt_pk_bf16_f32 v92, v92, v93
    v_cvt_pk_bf16_f32 v93, v94, v95
    ds_write_b64 v23, v[92:93] offset:648
    v_cvt_pk_bf16_f32 v96, v96, v97
    v_cvt_pk_bf16_f32 v97, v98, v99
    ds_write_b64 v22, v[96:97] offset:1280
    v_cvt_pk_bf16_f32 v100, v100, v101
    v_cvt_pk_bf16_f32 v101, v102, v103
    ds_write_b64 v22, v[100:101] offset:1288
    v_cvt_pk_bf16_f32 v104, v104, v105
    v_cvt_pk_bf16_f32 v105, v106, v107
    ds_write_b64 v22, v[104:105] offset:1920
    v_cvt_pk_bf16_f32 v108, v108, v109
    v_cvt_pk_bf16_f32 v109, v110, v111
    ds_write_b64 v22, v[108:109] offset:1928
    v_cvt_pk_bf16_f32 v112, v112, v113
    v_cvt_pk_bf16_f32 v113, v114, v115
    ds_write_b64 v23, v[112:113] offset:1280
    v_cvt_pk_bf16_f32 v116, v116, v117
    v_cvt_pk_bf16_f32 v117, v118, v119
    ds_write_b64 v23, v[116:117] offset:1288
    v_cvt_pk_bf16_f32 v120, v120, v121
    v_cvt_pk_bf16_f32 v121, v122, v123
    ds_write_b64 v23, v[120:121] offset:1920
    v_cvt_pk_bf16_f32 v124, v124, v125
    v_cvt_pk_bf16_f32 v125, v126, v127
    ds_write_b64 v23, v[124:125] offset:1928
    s_waitcnt lgkmcnt(0)
    s_barrier
    v_add_u32 v20, 0, v0
    v_mul_u32_u24 v22, 13108, v20
    v_lshrrev_b32 v22, 22, v22
    v_mul_u32_u24 v23, 320, v22
    v_sub_u32 v23, v20, v23
    v_mul_u32_u24 v21, 5120, v22
    v_lshl_add_u32 v21, v23, 3, v21
    v_mul_u32_u24 v22, 6554, v23
    v_lshrrev_b32 v22, 18, v22
    v_mul_u32_u24 v22, 40, v22
    v_sub_u32 v22, v23, v22
    v_lshrrev_b32 v22, 1, v22
    v_lshlrev_b32 v20, 3, v20
    v_add_u32 v24, 256, v0
    v_mul_u32_u24 v26, 13108, v24
    v_lshrrev_b32 v26, 22, v26
    v_mul_u32_u24 v27, 320, v26
    v_sub_u32 v27, v24, v27
    v_mul_u32_u24 v25, 5120, v26
    v_lshl_add_u32 v25, v27, 3, v25
    v_mul_u32_u24 v26, 6554, v27
    v_lshrrev_b32 v26, 18, v26
    v_mul_u32_u24 v26, 40, v26
    v_sub_u32 v26, v27, v26
    v_lshrrev_b32 v26, 1, v26
    v_lshlrev_b32 v24, 3, v24
    v_add_u32 v28, 512, v0
    v_mul_u32_u24 v30, 13108, v28
    v_lshrrev_b32 v30, 22, v30
    v_mul_u32_u24 v31, 320, v30
    v_sub_u32 v31, v28, v31
    v_mul_u32_u24 v29, 5120, v30
    v_lshl_add_u32 v29, v31, 3, v29
    v_mul_u32_u24 v30, 6554, v31
    v_lshrrev_b32 v30, 18, v30
    v_mul_u32_u24 v30, 40, v30
    v_sub_u32 v30, v31, v30
    v_lshrrev_b32 v30, 1, v30
    v_lshlrev_b32 v28, 3, v28
    s_add_u32 s52, s50, 0
    s_mul_i32 s52, s52, 163840
    s_lshl_b32 s53, s24, 1
    s_mul_i32 s53, s53, 5120
    s_add_u32 s52, s52, s53
    s_add_u32 s52, s52, 4196864
    s_sub_u32 s54, s51, 0
    s_add_u32 s55, s54, 128
    ds_read_b64 v[34:35], v20
    v_cmp_le_i32 vcc, s54, v22
    v_cmp_gt_i32 s[56:57], s55, v22
    s_and_b64 vcc, vcc, s[56:57]
    s_waitcnt lgkmcnt(0)
    s_mov_b64 exec, vcc
    buffer_store_dwordx2 v[34:35], v21, s[44:47], s52 offen
    s_mov_b64 exec, -1
    ds_read_b64 v[34:35], v24
    v_cmp_le_i32 vcc, s54, v26
    v_cmp_gt_i32 s[56:57], s55, v26
    s_and_b64 vcc, vcc, s[56:57]
    s_waitcnt lgkmcnt(0)
    s_mov_b64 exec, vcc
    buffer_store_dwordx2 v[34:35], v25, s[44:47], s52 offen
    s_mov_b64 exec, -1
    ds_read_b64 v[34:35], v28
    v_cmp_le_i32 vcc, s54, v30
    v_cmp_gt_i32 s[56:57], s55, v30
    s_and_b64 vcc, vcc, s[56:57]
    s_movk_i32 s59, 128
    v_cmp_gt_u32 s[56:57], s59, v0
    s_and_b64 vcc, vcc, s[56:57]
    s_waitcnt lgkmcnt(0)
    s_mov_b64 exec, vcc
    buffer_store_dwordx2 v[34:35], v29, s[44:47], s52 offen
    s_mov_b64 exec, -1
    s_add_u32 s52, s50, 1
    s_mul_i32 s52, s52, 163840
    s_lshl_b32 s53, s24, 1
    s_mul_i32 s53, s53, 5120
    s_add_u32 s52, s52, s53
    s_add_u32 s52, s52, 4196864
    s_sub_u32 s54, s51, 20
    s_add_u32 s55, s54, 128
    ds_read_b64 v[34:35], v20 offset:5120
    v_cmp_le_i32 vcc, s54, v22
    v_cmp_gt_i32 s[56:57], s55, v22
    s_and_b64 vcc, vcc, s[56:57]
    s_waitcnt lgkmcnt(0)
    s_mov_b64 exec, vcc
    buffer_store_dwordx2 v[34:35], v21, s[44:47], s52 offen
    s_mov_b64 exec, -1
    ds_read_b64 v[34:35], v24 offset:5120
    v_cmp_le_i32 vcc, s54, v26
    v_cmp_gt_i32 s[56:57], s55, v26
    s_and_b64 vcc, vcc, s[56:57]
    s_waitcnt lgkmcnt(0)
    s_mov_b64 exec, vcc
    buffer_store_dwordx2 v[34:35], v25, s[44:47], s52 offen
    s_mov_b64 exec, -1
    ds_read_b64 v[34:35], v28 offset:5120
    v_cmp_le_i32 vcc, s54, v30
    v_cmp_gt_i32 s[56:57], s55, v30
    s_and_b64 vcc, vcc, s[56:57]
    s_movk_i32 s59, 128
    v_cmp_gt_u32 s[56:57], s59, v0
    s_and_b64 vcc, vcc, s[56:57]
    s_waitcnt lgkmcnt(0)
    s_mov_b64 exec, vcc
    buffer_store_dwordx2 v[34:35], v29, s[44:47], s52 offen
    s_mov_b64 exec, -1
    s_add_u32 s52, s50, 2
    s_mul_i32 s52, s52, 163840
    s_lshl_b32 s53, s24, 1
    s_mul_i32 s53, s53, 5120
    s_add_u32 s52, s52, s53
    s_add_u32 s52, s52, 4196864
    s_sub_u32 s54, s51, 40
    s_add_u32 s55, s54, 128
    ds_read_b64 v[34:35], v20 offset:10240
    v_cmp_le_i32 vcc, s54, v22
    v_cmp_gt_i32 s[56:57], s55, v22
    s_and_b64 vcc, vcc, s[56:57]
    s_waitcnt lgkmcnt(0)
    s_mov_b64 exec, vcc
    buffer_store_dwordx2 v[34:35], v21, s[44:47], s52 offen
    s_mov_b64 exec, -1
    ds_read_b64 v[34:35], v24 offset:10240
    v_cmp_le_i32 vcc, s54, v26
    v_cmp_gt_i32 s[56:57], s55, v26
    s_and_b64 vcc, vcc, s[56:57]
    s_waitcnt lgkmcnt(0)
    s_mov_b64 exec, vcc
    buffer_store_dwordx2 v[34:35], v25, s[44:47], s52 offen
    s_mov_b64 exec, -1
    ds_read_b64 v[34:35], v28 offset:10240
    v_cmp_le_i32 vcc, s54, v30
    v_cmp_gt_i32 s[56:57], s55, v30
    s_and_b64 vcc, vcc, s[56:57]
    s_movk_i32 s59, 128
    v_cmp_gt_u32 s[56:57], s59, v0
    s_and_b64 vcc, vcc, s[56:57]
    s_waitcnt lgkmcnt(0)
    s_mov_b64 exec, vcc
    buffer_store_dwordx2 v[34:35], v29, s[44:47], s52 offen
    s_mov_b64 exec, -1
    s_add_u32 s52, s50, 3
    s_mul_i32 s52, s52, 163840
    s_lshl_b32 s53, s24, 1
    s_mul_i32 s53, s53, 5120
    s_add_u32 s52, s52, s53
    s_add_u32 s52, s52, 4196864
    s_sub_u32 s54, s51, 60
    s_add_u32 s55, s54, 128
    ds_read_b64 v[34:35], v20 offset:15360
    v_cmp_le_i32 vcc, s54, v22
    v_cmp_gt_i32 s[56:57], s55, v22
    s_and_b64 vcc, vcc, s[56:57]
    s_waitcnt lgkmcnt(0)
    s_mov_b64 exec, vcc
    buffer_store_dwordx2 v[34:35], v21, s[44:47], s52 offen
    s_mov_b64 exec, -1
    ds_read_b64 v[34:35], v24 offset:15360
    v_cmp_le_i32 vcc, s54, v26
    v_cmp_gt_i32 s[56:57], s55, v26
    s_and_b64 vcc, vcc, s[56:57]
    s_waitcnt lgkmcnt(0)
    s_mov_b64 exec, vcc
    buffer_store_dwordx2 v[34:35], v25, s[44:47], s52 offen
    s_mov_b64 exec, -1
    ds_read_b64 v[34:35], v28 offset:15360
    v_cmp_le_i32 vcc, s54, v30
    v_cmp_gt_i32 s[56:57], s55, v30
    s_and_b64 vcc, vcc, s[56:57]
    s_movk_i32 s59, 128
    v_cmp_gt_u32 s[56:57], s59, v0
    s_and_b64 vcc, vcc, s[56:57]
    s_waitcnt lgkmcnt(0)
    s_mov_b64 exec, vcc
    buffer_store_dwordx2 v[34:35], v29, s[44:47], s52 offen
    s_mov_b64 exec, -1
    s_add_u32 s52, s50, 4
    s_mul_i32 s52, s52, 163840
    s_lshl_b32 s53, s24, 1
    s_mul_i32 s53, s53, 5120
    s_add_u32 s52, s52, s53
    s_add_u32 s52, s52, 4196864
    s_sub_u32 s54, s51, 80
    s_add_u32 s55, s54, 128
    ds_read_b64 v[34:35], v20 offset:20480
    v_cmp_le_i32 vcc, s54, v22
    v_cmp_gt_i32 s[56:57], s55, v22
    s_and_b64 vcc, vcc, s[56:57]
    s_waitcnt lgkmcnt(0)
    s_mov_b64 exec, vcc
    buffer_store_dwordx2 v[34:35], v21, s[44:47], s52 offen
    s_mov_b64 exec, -1
    ds_read_b64 v[34:35], v24 offset:20480
    v_cmp_le_i32 vcc, s54, v26
    v_cmp_gt_i32 s[56:57], s55, v26
    s_and_b64 vcc, vcc, s[56:57]
    s_waitcnt lgkmcnt(0)
    s_mov_b64 exec, vcc
    buffer_store_dwordx2 v[34:35], v25, s[44:47], s52 offen
    s_mov_b64 exec, -1
    ds_read_b64 v[34:35], v28 offset:20480
    v_cmp_le_i32 vcc, s54, v30
    v_cmp_gt_i32 s[56:57], s55, v30
    s_and_b64 vcc, vcc, s[56:57]
    s_movk_i32 s59, 128
    v_cmp_gt_u32 s[56:57], s59, v0
    s_and_b64 vcc, vcc, s[56:57]
    s_waitcnt lgkmcnt(0)
    s_mov_b64 exec, vcc
    buffer_store_dwordx2 v[34:35], v29, s[44:47], s52 offen
    s_mov_b64 exec, -1
    s_add_u32 s52, s50, 5
    s_mul_i32 s52, s52, 163840
    s_lshl_b32 s53, s24, 1
    s_mul_i32 s53, s53, 5120
    s_add_u32 s52, s52, s53
    s_add_u32 s52, s52, 4196864
    s_sub_u32 s54, s51, 100
    s_add_u32 s55, s54, 128
    ds_read_b64 v[34:35], v20 offset:25600
    v_cmp_le_i32 vcc, s54, v22
    v_cmp_gt_i32 s[56:57], s55, v22
    s_and_b64 vcc, vcc, s[56:57]
    s_waitcnt lgkmcnt(0)
    s_mov_b64 exec, vcc
    buffer_store_dwordx2 v[34:35], v21, s[44:47], s52 offen
    s_mov_b64 exec, -1
    ds_read_b64 v[34:35], v24 offset:25600
    v_cmp_le_i32 vcc, s54, v26
    v_cmp_gt_i32 s[56:57], s55, v26
    s_and_b64 vcc, vcc, s[56:57]
    s_waitcnt lgkmcnt(0)
    s_mov_b64 exec, vcc
    buffer_store_dwordx2 v[34:35], v25, s[44:47], s52 offen
    s_mov_b64 exec, -1
    ds_read_b64 v[34:35], v28 offset:25600
    v_cmp_le_i32 vcc, s54, v30
    v_cmp_gt_i32 s[56:57], s55, v30
    s_and_b64 vcc, vcc, s[56:57]
    s_movk_i32 s59, 128
    v_cmp_gt_u32 s[56:57], s59, v0
    s_and_b64 vcc, vcc, s[56:57]
    s_waitcnt lgkmcnt(0)
    s_mov_b64 exec, vcc
    buffer_store_dwordx2 v[34:35], v29, s[44:47], s52 offen
    s_mov_b64 exec, -1
    s_add_u32 s52, s50, 6
    s_mul_i32 s52, s52, 163840
    s_lshl_b32 s53, s24, 1
    s_mul_i32 s53, s53, 5120
    s_add_u32 s52, s52, s53
    s_add_u32 s52, s52, 4196864
    s_sub_u32 s54, s51, 120
    s_add_u32 s55, s54, 128
    ds_read_b64 v[34:35], v20 offset:30720
    v_cmp_le_i32 vcc, s54, v22
    v_cmp_gt_i32 s[56:57], s55, v22
    s_and_b64 vcc, vcc, s[56:57]
    s_waitcnt lgkmcnt(0)
    s_mov_b64 exec, vcc
    buffer_store_dwordx2 v[34:35], v21, s[44:47], s52 offen
    s_mov_b64 exec, -1
    ds_read_b64 v[34:35], v24 offset:30720
    v_cmp_le_i32 vcc, s54, v26
    v_cmp_gt_i32 s[56:57], s55, v26
    s_and_b64 vcc, vcc, s[56:57]
    s_waitcnt lgkmcnt(0)
    s_mov_b64 exec, vcc
    buffer_store_dwordx2 v[34:35], v25, s[44:47], s52 offen
    s_mov_b64 exec, -1
    ds_read_b64 v[34:35], v28 offset:30720
    v_cmp_le_i32 vcc, s54, v30
    v_cmp_gt_i32 s[56:57], s55, v30
    s_and_b64 vcc, vcc, s[56:57]
    s_movk_i32 s59, 128
    v_cmp_gt_u32 s[56:57], s59, v0
    s_and_b64 vcc, vcc, s[56:57]
    s_waitcnt lgkmcnt(0)
    s_mov_b64 exec, vcc
    buffer_store_dwordx2 v[34:35], v29, s[44:47], s52 offen
    s_mov_b64 exec, -1
    s_add_u32 s52, s50, 7
    s_mul_i32 s52, s52, 163840
    s_lshl_b32 s53, s24, 1
    s_mul_i32 s53, s53, 5120
    s_add_u32 s52, s52, s53
    s_add_u32 s52, s52, 4196864
    s_sub_u32 s54, s51, 140
    s_add_u32 s55, s54, 128
    ds_read_b64 v[34:35], v20 offset:35840
    v_cmp_le_i32 vcc, s54, v22
    v_cmp_gt_i32 s[56:57], s55, v22
    s_and_b64 vcc, vcc, s[56:57]
    s_waitcnt lgkmcnt(0)
    s_mov_b64 exec, vcc
    buffer_store_dwordx2 v[34:35], v21, s[44:47], s52 offen
    s_mov_b64 exec, -1
    ds_read_b64 v[34:35], v24 offset:35840
    v_cmp_le_i32 vcc, s54, v26
    v_cmp_gt_i32 s[56:57], s55, v26
    s_and_b64 vcc, vcc, s[56:57]
    s_waitcnt lgkmcnt(0)
    s_mov_b64 exec, vcc
    buffer_store_dwordx2 v[34:35], v25, s[44:47], s52 offen
    s_mov_b64 exec, -1
    ds_read_b64 v[34:35], v28 offset:35840
    v_cmp_le_i32 vcc, s54, v30
    v_cmp_gt_i32 s[56:57], s55, v30
    s_and_b64 vcc, vcc, s[56:57]
    s_movk_i32 s59, 128
    v_cmp_gt_u32 s[56:57], s59, v0
    s_and_b64 vcc, vcc, s[56:57]
    s_waitcnt lgkmcnt(0)
    s_mov_b64 exec, vcc
    buffer_store_dwordx2 v[34:35], v29, s[44:47], s52 offen
    s_mov_b64 exec, -1
L_mha_qkv_kernel_end:
    s_endpgm
.globl mha_attn_kernel
.p2align 8
.type mha_attn_kernel,@function
mha_attn_kernel:
    s_cmp_ge_u32 s2, 256
    s_cbranch_scc1 L_mha_attn_kernel_end
    s_load_dwordx2 s[26:27], s[0:1], 40
    v_and_b32 v1, 63, v0
    v_lshrrev_b32 v134, 6, v0
    s_nop 0
    v_readfirstlane_b32 s20, v134
    s_and_b32 s21, s2, 7
    s_lshl_b32 s21, s21, 2
    s_lshr_b32 s22, s2, 3
    s_and_b32 s23, s22, 3
    s_add_u32 s24, s21, s23
    s_lshr_b32 s25, s2, 5
    s_waitcnt lgkmcnt(0)
    s_mov_b32 s44, s26
    s_mov_b32 s45, s27
    s_mov_b32 s46, 268435456
    s_mov_b32 s47, 0x00020000
    s_mul_i32 s31, s24, 163840
    s_add_u32 s31, s31, 4194304
    s_lshl_b32 s32, s20, 10
    s_add_u32 s31, s31, s32
    v_lshlrev_b32 v136, 4, v1
    s_add_u32 m0, s32, 0
    s_add_u32 s33, s31, 0
    buffer_load_dwordx4 v136, s[44:47], s33 offen lds
    s_add_u32 m0, s32, 8192
    s_add_u32 s33, s31, 8192
    buffer_load_dwordx4 v136, s[44:47], s33 offen lds
    s_lshl_b32 s30, s24, 11
    s_lshl_b32 s38, s25, 8
    s_add_u32 s30, s30, s38
    s_lshl_b32 s38, s20, 5
    s_add_u32 s30, s30, s38
    s_mul_i32 s30, s30, 40
    v_and_b32 v134, 31, v1
    v_mul_u32_u24 v134, 40, v134
    v_lshrrev_b32 v135, 5, v1
    v_lshl_add_u32 v135, v135, 4, v134
    v_mov_b32 v8, 0
    v_mov_b32 v9, 0
    v_mov_b32 v10, 0
    v_mov_b32 v11, 0
    buffer_load_dwordx4 v[4:7], v135, s[44:47], s30 offen
    s_mov_b64 exec, 0xffffffff
    buffer_load_dwordx2 v[8:9], v134, s[44:47], s30 offen offset:32
    s_mov_b64 exec, -1
    s_add_u32 m0, s32, 16384
    s_add_u32 s33, s31, 16384
    buffer_load_dwordx4 v136, s[44:47], s33 offen lds
    v_lshlrev_b32 v124, 4, v1
    v_and_b32 v134, 31, v1
    v_lshlrev_b32 v127, 3, v134
    v_add_u32 v127, 2048, v127
    v_lshrrev_b32 v135, 5, v1
    v_mul_u32_u24 v135, 320, v135
    v_lshl_add_u32 v130, v134, 4, v135
    v_add_u32 v130, 2560, v130
    v_add_u32 v125, 61440, v124
    v_add_u32 v128, 61440, v127
    v_add_u32 v131, 61440, v130
    v_add_u32 v126, 122880, v124
    v_add_u32 v129, 122880, v127
    v_add_u32 v132, 122880, v130
    s_mov_b32 s34, 0x000fffff
    s_mov_b32 s35, 0x000fffff
    v_mov_b32 v102, 0
    v_mov_b32 v103, 0
    v_mov_b32 v106, 0
    v_mov_b32 v107, 0
    v_cmp_eq_u32 vcc, 20, v134
    v_mov_b32 v137, 0
    v_mov_b32 v138, 0x3f803f80
    s_nop 0
    v_cndmask_b32 v137, v137, v138, vcc
    v_mov_b32 v108, v137
    v_mov_b32 v109, v137
    v_mov_b32 v110, v137
    v_mov_b32 v111, v137
    v_mov_b32 v112, v137
    v_mov_b32 v113, v137
    v_mov_b32 v114, v137
    v_mov_b32 v115, v137
    v_mov_b32 v116, v137
    v_mov_b32 v117, v137
    v_mov_b32 v118, v137
    v_mov_b32 v119, v137
    v_mov_b32 v120, v137
    v_mov_b32 v121, v137
    v_mov_b32 v122, v137
    v_mov_b32 v123, v137
    v_mov_b32 v12, 0
    v_mov_b32 v76, 0
    v_mov_b32 v13, 0
    v_mov_b32 v77, 0
    v_mov_b32 v14, 0
    v_mov_b32 v78, 0
    v_mov_b32 v15, 0
    v_mov_b32 v79, 0
    v_mov_b32 v16, 0
    v_mov_b32 v80, 0
    v_mov_b32 v17, 0
    v_mov_b32 v81, 0
    v_mov_b32 v18, 0
    v_mov_b32 v82, 0
    v_mov_b32 v19, 0
    v_mov_b32 v83, 0
    v_mov_b32 v20, 0
    v_mov_b32 v84, 0
    v_mov_b32 v21, 0
    v_mov_b32 v85, 0
    v_mov_b32 v22, 0
    v_mov_b32 v86, 0
    v_mov_b32 v23, 0
    v_mov_b32 v87, 0
    v_mov_b32 v24, 0
    v_mov_b32 v88, 0
    v_mov_b32 v25, 0
    v_mov_b32 v89, 0
    v_mov_b32 v26, 0
    v_mov_b32 v90, 0
    v_mov_b32 v27, 0
    v_mov_b32 v91, 0
    s_waitcnt vmcnt(1)
    s_barrier
    ds_read_b128 v[92:95], v124
    ds_read_b64 v[100:101], v127
    ds_read_b128 v[96:99], v124 offset:1024
    ds_read_b64 v[104:105], v127 offset:256
    s_waitcnt lgkmcnt(0)
    v_mfma_f32_32x32x16_bf16 v[28:43], v[92:95], v[4:7], v[12:27]
    v_mfma_f32_32x32x16_bf16 v[28:43], v[100:103], v[8:11], v[28:43]
    v_mfma_f32_32x32x16_bf16 v[44:59], v[96:99], v[4:7], v[12:27]
    v_mfma_f32_32x32x16_bf16 v[44:59], v[104:107], v[8:11], v[44:59]
    s_nop 15
    v_max3_f32 v134, v28, v29, v30
    v_max3_f32 v134, v134, v31, v32
    v_max3_f32 v134, v134, v33, v34
    v_max3_f32 v134, v134, v35, v36
    v_max3_f32 v134, v134, v37, v38
    v_max3_f32 v134, v134, v39, v40
    v_max3_f32 v134, v134, v41, v42
    v_max3_f32 v134, v134, v43, v44
    v_max3_f32 v134, v134, v45, v46
    v_max3_f32 v134, v134, v47, v48
    v_max3_f32 v134, v134, v49, v50
    v_max3_f32 v134, v134, v51, v52
    v_max3_f32 v134, v134, v53, v54
    v_max3_f32 v134, v134, v55, v56
    v_max3_f32 v134, v134, v57, v58
    v_max_f32 v134, v134, v59
    v_mov_b32 v135, v134
    s_nop 1
    v_permlane32_swap_b32 v134, v135
    s_nop 1
    v_max_f32 v134, v134, v135
    v_sub_f32 v134, 0, v134
    v_mov_b32 v12, v134
    v_mov_b32 v13, v134
    v_mov_b32 v14, v134
    v_mov_b32 v15, v134
    v_mov_b32 v16, v134
    v_mov_b32 v17, v134
    v_mov_b32 v18, v134
    v_mov_b32 v19, v134
    v_mov_b32 v20, v134
    v_mov_b32 v21, v134
    v_mov_b32 v22, v134
    v_mov_b32 v23, v134
    v_mov_b32 v24, v134
    v_mov_b32 v25, v134
    v_mov_b32 v26, v134
    v_mov_b32 v27, v134
    s_nop 1
    v_mfma_f32_32x32x16_bf16 v[28:43], v[92:95], v[4:7], v[12:27]
    v_mfma_f32_32x32x16_bf16 v[28:43], v[100:103], v[8:11], v[28:43]
    s_mov_b64 exec, s[34:35]
    ds_read_b128 v[108:111], v130
    ds_read_b128 v[112:115], v130 offset:640
    s_mov_b64 exec, -1
    v_exp_f32 v28, v28
    v_exp_f32 v29, v29
    v_exp_f32 v30, v30
    v_exp_f32 v31, v31
    v_mfma_f32_32x32x16_bf16 v[44:59], v[96:99], v[4:7], v[12:27]
    v_exp_f32 v32, v32
    v_exp_f32 v33, v33
    v_exp_f32 v34, v34
    v_exp_f32 v35, v35
    v_exp_f32 v36, v36
    v_exp_f32 v37, v37
    v_exp_f32 v38, v38
    v_exp_f32 v39, v39
    v_mfma_f32_32x32x16_bf16 v[44:59], v[104:107], v[8:11], v[44:59]
    v_exp_f32 v40, v40
    v_exp_f32 v41, v41
    v_exp_f32 v42, v42
    v_exp_f32 v43, v43
    ds_read_b128 v[92:95], v124 offset:5120
    ds_read_b64 v[100:101], v127 offset:5120
    s_mov_b64 exec, s[34:35]
    ds_read_b128 v[116:119], v130 offset:1280
    ds_read_b128 v[120:123], v130 offset:1920
    s_mov_b64 exec, -1
    v_cvt_pk_bf16_f32 v60, v28, v29
    v_cvt_pk_bf16_f32 v61, v30, v31
    v_cvt_pk_bf16_f32 v62, v32, v33
    v_cvt_pk_bf16_f32 v63, v34, v35
    v_cvt_pk_bf16_f32 v64, v36, v37
    v_cvt_pk_bf16_f32 v65, v38, v39
    v_cvt_pk_bf16_f32 v66, v40, v41
    v_cvt_pk_bf16_f32 v67, v42, v43
    s_waitcnt lgkmcnt(4)
    s_nop 0
    s_waitcnt lgkmcnt(2)
    v_exp_f32 v44, v44
    v_exp_f32 v45, v45
    v_exp_f32 v46, v46
    v_exp_f32 v47, v47
    v_mfma_f32_32x32x16_bf16 v[28:43], v[92:95], v[4:7], v[12:27]
    v_exp_f32 v48, v48
    v_exp_f32 v49, v49
    v_exp_f32 v50, v50
    v_exp_f32 v51, v51
    v_mfma_f32_32x32x16_bf16 v[76:91], v[108:111], v[60:63], v[76:91]
    v_exp_f32 v52, v52
    v_exp_f32 v53, v53
    v_exp_f32 v54, v54
    v_exp_f32 v55, v55
    v_mfma_f32_32x32x16_bf16 v[28:43], v[100:103], v[8:11], v[28:43]
    v_exp_f32 v56, v56
    v_exp_f32 v57, v57
    v_exp_f32 v58, v58
    v_exp_f32 v59, v59
    v_mfma_f32_32x32x16_bf16 v[76:91], v[112:115], v[64:67], v[76:91]
    ds_read_b128 v[96:99], v124 offset:6144
    ds_read_b64 v[104:105], v127 offset:5376
    s_mov_b64 exec, s[34:35]
    ds_read_b128 v[108:111], v130 offset:5120
    ds_read_b128 v[112:115], v130 offset:5760
    s_mov_b64 exec, -1
    s_add_u32 m0, s32, 24576
    s_add_u32 s33, s31, 24576
    buffer_load_dwordx4 v136, s[44:47], s33 offen lds
    v_cvt_pk_bf16_f32 v68, v44, v45
    v_cvt_pk_bf16_f32 v69, v46, v47
    v_cvt_pk_bf16_f32 v70, v48, v49
    v_cvt_pk_bf16_f32 v71, v50, v51
    v_cvt_pk_bf16_f32 v72, v52, v53
    v_cvt_pk_bf16_f32 v73, v54, v55
    v_cvt_pk_bf16_f32 v74, v56, v57
    v_cvt_pk_bf16_f32 v75, v58, v59
    s_waitcnt lgkmcnt(4)
    s_nop 0
    s_waitcnt lgkmcnt(2)
    v_exp_f32 v28, v28
    v_exp_f32 v29, v29
    v_exp_f32 v30, v30
    v_exp_f32 v31, v31
    v_mfma_f32_32x32x16_bf16 v[44:59], v[96:99], v[4:7], v[12:27]
    v_exp_f32 v32, v32
    v_exp_f32 v33, v33
    v_exp_f32 v34, v34
    v_exp_f32 v35, v35
    v_mfma_f32_32x32x16_bf16 v[76:91], v[116:119], v[68:71], v[76:91]
    v_exp_f32 v36, v36
    v_exp_f32 v37, v37
    v_exp_f32 v38, v38
    v_exp_f32 v39, v39
    v_mfma_f32_32x32x16_bf16 v[44:59], v[104:107], v[8:11], v[44:59]
    v_exp_f32 v40, v40
    v_exp_f32 v41, v41
    v_exp_f32 v42, v42
    v_exp_f32 v43, v43
    v_mfma_f32_32x32x16_bf16 v[76:91], v[120:123], v[72:75], v[76:91]
    s_waitcnt vmcnt(1)
    s_barrier
    ds_read_b128 v[92:95], v124 offset:10240
    ds_read_b64 v[100:101], v127 offset:10240
    s_mov_b64 exec, s[34:35]
    ds_read_b128 v[116:119], v130 offset:6400
    ds_read_b128 v[120:123], v130 offset:7040
    s_mov_b64 exec, -1
    v_cvt_pk_bf16_f32 v60, v28, v29
    v_cvt_pk_bf16_f32 v61, v30, v31
    v_cvt_pk_bf16_f32 v62, v32, v33
    v_cvt_pk_bf16_f32 v63, v34, v35
    v_cvt_pk_bf16_f32 v64, v36, v37
    v_cvt_pk_bf16_f32 v65, v38, v39
    v_cvt_pk_bf16_f32 v66, v40, v41
    v_cvt_pk_bf16_f32 v67, v42, v43
    s_waitcnt lgkmcnt(4)
    s_nop 0
    s_waitcnt lgkmcnt(2)
    v_exp_f32 v44, v44
    v_exp_f32 v45, v45
    v_exp_f32 v46, v46
    v_exp_f32 v47, v47
    v_mfma_f32_32x32x16_bf16 v[28:43], v[92:95], v[4:7], v[12:27]
    v_exp_f32 v48, v48
    v_exp_f32 v49, v49
    v_exp_f32 v50, v50
    v_exp_f32 v51, v51
    v_mfma_f32_32x32x16_bf16 v[76:91], v[108:111], v[60:63], v[76:91]
    v_exp_f32 v52, v52
    v_exp_f32 v53, v53
    v_exp_f32 v54, v54
    v_exp_f32 v55, v55
    v_mfma_f32_32x32x16_bf16 v[28:43], v[100:103], v[8:11], v[28:43]
    v_exp_f32 v56, v56
    v_exp_f32 v57, v57
    v_exp_f32 v58, v58
    v_exp_f32 v59, v59
    v_mfma_f32_32x32x16_bf16 v[76:91], v[112:115], v[64:67], v[76:91]
    ds_read_b128 v[96:99], v124 offset:11264
    ds_read_b64 v[104:105], v127 offset:10496
    s_mov_b64 exec, s[34:35]
    ds_read_b128 v[108:111], v130 offset:10240
    ds_read_b128 v[112:115], v130 offset:10880
    s_mov_b64 exec, -1
    s_add_u32 m0, s32, 32768
    s_add_u32 s33, s31, 32768
    buffer_load_dwordx4 v136, s[44:47], s33 offen lds
    v_cvt_pk_bf16_f32 v68, v44, v45
    v_cvt_pk_bf16_f32 v69, v46, v47
    v_cvt_pk_bf16_f32 v70, v48, v49
    v_cvt_pk_bf16_f32 v71, v50, v51
    v_cvt_pk_bf16_f32 v72, v52, v53
    v_cvt_pk_bf16_f32 v73, v54, v55
    v_cvt_pk_bf16_f32 v74, v56, v57
    v_cvt_pk_bf16_f32 v75, v58, v59
    s_waitcnt lgkmcnt(4)
    s_nop 0
    s_waitcnt lgkmcnt(2)
    v_exp_f32 v28, v28
    v_exp_f32 v29, v29
    v_exp_f32 v30, v30
    v_exp_f32 v31, v31
    v_mfma_f32_32x32x16_bf16 v[44:59], v[96:99], v[4:7], v[12:27]
    v_exp_f32 v32, v32
    v_exp_f32 v33, v33
    v_exp_f32 v34, v34
    v_exp_f32 v35, v35
    v_mfma_f32_32x32x16_bf16 v[76:91], v[116:119], v[68:71], v[76:91]
    v_exp_f32 v36, v36
    v_exp_f32 v37, v37
    v_exp_f32 v38, v38
    v_exp_f32 v39, v39
    v_mfma_f32_32x32x16_bf16 v[44:59], v[104:107], v[8:11], v[44:59]
    v_exp_f32 v40, v40
    v_exp_f32 v41, v41
    v_exp_f32 v42, v42
    v_exp_f32 v43, v43
    v_mfma_f32_32x32x16_bf16 v[76:91], v[120:123], v[72:75], v[76:91]
    ds_read_b128 v[92:95], v124 offset:15360
    ds_read_b64 v[100:101], v127 offset:15360
    s_mov_b64 exec, s[34:35]
    ds_read_b128 v[116:119], v130 offset:11520
    ds_read_b128 v[120:123], v130 offset:12160
    s_mov_b64 exec, -1
    v_cvt_pk_bf16_f32 v60, v28, v29
    v_cvt_pk_bf16_f32 v61, v30, v31
    v_cvt_pk_bf16_f32 v62, v32, v33
    v_cvt_pk_bf16_f32 v63, v34, v35
    v_cvt_pk_bf16_f32 v64, v36, v37
    v_cvt_pk_bf16_f32 v65, v38, v39
    v_cvt_pk_bf16_f32 v66, v40, v41
    v_cvt_pk_bf16_f32 v67, v42, v43
    s_waitcnt lgkmcnt(4)
    s_nop 0
    s_waitcnt lgkmcnt(2)
    v_exp_f32 v44, v44
    v_exp_f32 v45, v45
    v_exp_f32 v46, v46
    v_exp_f32 v47, v47
    v_mfma_f32_32x32x16_bf16 v[28:43], v[92:95], v[4:7], v[12:27]
    v_exp_f32 v48, v48
    v_exp_f32 v49, v49
    v_exp_f32 v50, v50
    v_exp_f32 v51, v51
    v_mfma_f32_32x32x16_bf16 v[76:91], v[108:111], v[60:63], v[76:91]
    v_exp_f32 v52, v52
    v_exp_f32 v53, v53
    v_exp_f32 v54, v54
    v_exp_f32 v55, v55
    v_mfma_f32_32x32x16_bf16 v[28:43], v[100:103], v[8:11], v[28:43]
    v_exp_f32 v56, v56
    v_exp_f32 v57, v57
    v_exp_f32 v58, v58
    v_exp_f32 v59, v59
    v_mfma_f32_32x32x16_bf16 v[76:91], v[112:115], v[64:67], v[76:91]
    ds_read_b128 v[96:99], v124 offset:16384
    ds_read_b64 v[104:105], v127 offset:15616
    s_mov_b64 exec, s[34:35]
    ds_read_b128 v[108:111], v130 offset:15360
    ds_read_b128 v[112:115], v130 offset:16000
    s_mov_b64 exec, -1
    s_add_u32 m0, s32, 40960
    s_add_u32 s33, s31, 40960
    buffer_load_dwordx4 v136, s[44:47], s33 offen lds
    v_cvt_pk_bf16_f32 v68, v44, v45
    v_cvt_pk_bf16_f32 v69, v46, v47
    v_cvt_pk_bf16_f32 v70, v48, v49
    v_cvt_pk_bf16_f32 v71, v50, v51
    v_cvt_pk_bf16_f32 v72, v52, v53
    v_cvt_pk_bf16_f32 v73, v54, v55
    v_cvt_pk_bf16_f32 v74, v56, v57
    v_cvt_pk_bf16_f32 v75, v58, v59
    s_waitcnt lgkmcnt(4)
    s_nop 0
    s_waitcnt lgkmcnt(2)
    v_exp_f32 v28, v28
    v_exp_f32 v29, v29
    v_exp_f32 v30, v30
    v_exp_f32 v31, v31
    v_mfma_f32_32x32x16_bf16 v[44:59], v[96:99], v[4:7], v[12:27]
    v_exp_f32 v32, v32
    v_exp_f32 v33, v33
    v_exp_f32 v34, v34
    v_exp_f32 v35, v35
    v_mfma_f32_32x32x16_bf16 v[76:91], v[116:119], v[68:71], v[76:91]
    v_exp_f32 v36, v36
    v_exp_f32 v37, v37
    v_exp_f32 v38, v38
    v_exp_f32 v39, v39
    v_mfma_f32_32x32x16_bf16 v[44:59], v[104:107], v[8:11], v[44:59]
    v_exp_f32 v40, v40
    v_exp_f32 v41, v41
    v_exp_f32 v42, v42
    v_exp_f32 v43, v43
    v_mfma_f32_32x32x16_bf16 v[76:91], v[120:123], v[72:75], v[76:91]
    s_waitcnt vmcnt(2)
    s_barrier
    ds_read_b128 v[92:95], v124 offset:20480
    ds_read_b64 v[100:101], v127 offset:20480
    s_mov_b64 exec, s[34:35]
    ds_read_b128 v[116:119], v130 offset:16640
    ds_read_b128 v[120:123], v130 offset:17280
    s_mov_b64 exec, -1
    v_cvt_pk_bf16_f32 v60, v28, v29
    v_cvt_pk_bf16_f32 v61, v30, v31
    v_cvt_pk_bf16_f32 v62, v32, v33
    v_cvt_pk_bf16_f32 v63, v34, v35
    v_cvt_pk_bf16_f32 v64, v36, v37
    v_cvt_pk_bf16_f32 v65, v38, v39
    v_cvt_pk_bf16_f32 v66, v40, v41
    v_cvt_pk_bf16_f32 v67, v42, v43
    s_waitcnt lgkmcnt(4)
    s_nop 0
    s_waitcnt lgkmcnt(2)
    v_exp_f32 v44, v44
    v_exp_f32 v45, v45
    v_exp_f32 v46, v46
    v_exp_f32 v47, v47
    v_mfma_f32_32x32x16_bf16 v[28:43], v[92:95], v[4:7], v[12:27]
    v_exp_f32 v48, v48
    v_exp_f32 v49, v49
    v_exp_f32 v50, v50
    v_exp_f32 v51, v51
    v_mfma_f32_32x32x16_bf16 v[76:91], v[108:111], v[60:63], v[76:91]
    v_exp_f32 v52, v52
    v_exp_f32 v53, v53
    v_exp_f32 v54, v54
    v_exp_f32 v55, v55
    v_mfma_f32_32x32x16_bf16 v[28:43], v[100:103], v[8:11], v[28:43]
    v_exp_f32 v56, v56
    v_exp_f32 v57, v57
    v_exp_f32 v58, v58
    v_exp_f32 v59, v59
    v_mfma_f32_32x32x16_bf16 v[76:91], v[112:115], v[64:67], v[76:91]
    ds_read_b128 v[96:99], v124 offset:21504
    ds_read_b64 v[104:105], v127 offset:20736
    s_mov_b64 exec, s[34:35]
    ds_read_b128 v[108:111], v130 offset:20480
    ds_read_b128 v[112:115], v130 offset:21120
    s_mov_b64 exec, -1
    s_add_u32 m0, s32, 49152
    s_add_u32 s33, s31, 49152
    buffer_load_dwordx4 v136, s[44:47], s33 offen lds
    v_cvt_pk_bf16_f32 v68, v44, v45
    v_cvt_pk_bf16_f32 v69, v46, v47
    v_cvt_pk_bf16_f32 v70, v48, v49
    v_cvt_pk_bf16_f32 v71, v50, v51
    v_cvt_pk_bf16_f32 v72, v52, v53
    v_cvt_pk_bf16_f32 v73, v54, v55
    v_cvt_pk_bf16_f32 v74, v56, v57
    v_cvt_pk_bf16_f32 v75, v58, v59
    s_waitcnt lgkmcnt(4)
    s_nop 0
    s_waitcnt lgkmcnt(2)
    v_exp_f32 v28, v28
    v_exp_f32 v29, v29
    v_exp_f32 v30, v30
    v_exp_f32 v31, v31
    v_mfma_f32_32x32x16_bf16 v[44:59], v[96:99], v[4:7], v[12:27]
    v_exp_f32 v32, v32
    v_exp_f32 v33, v33
    v_exp_f32 v34, v34
    v_exp_f32 v35, v35
    v_mfma_f32_32x32x16_bf16 v[76:91], v[116:119], v[68:71], v[76:91]
    v_exp_f32 v36, v36
    v_exp_f32 v37, v37
    v_exp_f32 v38, v38
    v_exp_f32 v39, v39
    v_mfma_f32_32x32x16_bf16 v[44:59], v[104:107], v[8:11], v[44:59]
    v_exp_f32 v40, v40
    v_exp_f32 v41, v41
    v_exp_f32 v42, v42
    v_exp_f32 v43, v43
    v_mfma_f32_32x32x16_bf16 v[76:91], v[120:123], v[72:75], v[76:91]
    ds_read_b128 v[92:95], v124 offset:25600
    ds_read_b64 v[100:101], v127 offset:25600
    s_mov_b64 exec, s[34:35]
    ds_read_b128 v[116:119], v130 offset:21760
    ds_read_b128 v[120:123], v130 offset:22400
    s_mov_b64 exec, -1
    v_cvt_pk_bf16_f32 v60, v28, v29
    v_cvt_pk_bf16_f32 v61, v30, v31
    v_cvt_pk_bf16_f32 v62, v32, v33
    v_cvt_pk_bf16_f32 v63, v34, v35
    v_cvt_pk_bf16_f32 v64, v36, v37
    v_cvt_pk_bf16_f32 v65, v38, v39
    v_cvt_pk_bf16_f32 v66, v40, v41
    v_cvt_pk_bf16_f32 v67, v42, v43
    s_waitcnt lgkmcnt(4)
    s_nop 0
    s_waitcnt lgkmcnt(2)
    v_exp_f32 v44, v44
    v_exp_f32 v45, v45
    v_exp_f32 v46, v46
    v_exp_f32 v47, v47
    v_mfma_f32_32x32x16_bf16 v[28:43], v[92:95], v[4:7], v[12:27]
    v_exp_f32 v48, v48
    v_exp_f32 v49, v49
    v_exp_f32 v50, v50
    v_exp_f32 v51, v51
    v_mfma_f32_32x32x16_bf16 v[76:91], v[108:111], v[60:63], v[76:91]
    v_exp_f32 v52, v52
    v_exp_f32 v53, v53
    v_exp_f32 v54, v54
    v_exp_f32 v55, v55
    v_mfma_f32_32x32x16_bf16 v[28:43], v[100:103], v[8:11], v[28:43]
    v_exp_f32 v56, v56
    v_exp_f32 v57, v57
    v_exp_f32 v58, v58
    v_exp_f32 v59, v59
    v_mfma_f32_32x32x16_bf16 v[76:91], v[112:115], v[64:67], v[76:91]
    ds_read_b128 v[96:99], v124 offset:26624
    ds_read_b64 v[104:105], v127 offset:25856
    s_mov_b64 exec, s[34:35]
    ds_read_b128 v[108:111], v130 offset:25600
    ds_read_b128 v[112:115], v130 offset:26240
    s_mov_b64 exec, -1
    s_add_u32 m0, s32, 57344
    s_add_u32 s33, s31, 57344
    buffer_load_dwordx4 v136, s[44:47], s33 offen lds
    v_cvt_pk_bf16_f32 v68, v44, v45
    v_cvt_pk_bf16_f32 v69, v46, v47
    v_cvt_pk_bf16_f32 v70, v48, v49
    v_cvt_pk_bf16_f32 v71, v50, v51
    v_cvt_pk_bf16_f32 v72, v52, v53
    v_cvt_pk_bf16_f32 v73, v54, v55
    v_cvt_pk_bf16_f32 v74, v56, v57
    v_cvt_pk_bf16_f32 v75, v58, v59
    s_waitcnt lgkmcnt(4)
    s_nop 0
    s_waitcnt lgkmcnt(2)
    v_exp_f32 v28, v28
    v_exp_f32 v29, v29
    v_exp_f32 v30, v30
    v_exp_f32 v31, v31
    v_mfma_f32_32x32x16_bf16 v[44:59], v[96:99], v[4:7], v[12:27]
    v_exp_f32 v32, v32
    v_exp_f32 v33, v33
    v_exp_f32 v34, v34
    v_exp_f32 v35, v35
    v_mfma_f32_32x32x16_bf16 v[76:91], v[116:119], v[68:71], v[76:91]
    v_exp_f32 v36, v36
    v_exp_f32 v37, v37
    v_exp_f32 v38, v38
    v_exp_f32 v39, v39
    v_mfma_f32_32x32x16_bf16 v[44:59], v[104:107], v[8:11], v[44:59]
    v_exp_f32 v40, v40
    v_exp_f32 v41, v41
    v_exp_f32 v42, v42
    v_exp_f32 v43, v43
    v_mfma_f32_32x32x16_bf16 v[76:91], v[120:123], v[72:75], v[76:91]
    s_waitcnt vmcnt(3)
    s_barrier
    ds_read_b128 v[92:95], v124 offset:30720
    ds_read_b64 v[100:101], v127 offset:30720
    s_mov_b64 exec, s[34:35]
    ds_read_b128 v[116:119], v130 offset:26880
    ds_read_b128 v[120:123], v130 offset:27520
    s_mov_b64 exec, -1
    v_cvt_pk_bf16_f32 v60, v28, v29
    v_cvt_pk_bf16_f32 v61, v30, v31
    v_cvt_pk_bf16_f32 v62, v32, v33
    v_cvt_pk_bf16_f32 v63, v34, v35
    v_cvt_pk_bf16_f32 v64, v36, v37
    v_cvt_pk_bf16_f32 v65, v38, v39
    v_cvt_pk_bf16_f32 v66, v40, v41
    v_cvt_pk_bf16_f32 v67, v42, v43
    s_waitcnt lgkmcnt(4)
    s_nop 0
    s_waitcnt lgkmcnt(2)
    v_exp_f32 v44, v44
    v_exp_f32 v45, v45
    v_exp_f32 v46, v46
    v_exp_f32 v47, v47
    v_mfma_f32_32x32x16_bf16 v[28:43], v[92:95], v[4:7], v[12:27]
    v_exp_f32 v48, v48
    v_exp_f32 v49, v49
    v_exp_f32 v50, v50
    v_exp_f32 v51, v51
    v_mfma_f32_32x32x16_bf16 v[76:91], v[108:111], v[60:63], v[76:91]
    v_exp_f32 v52, v52
    v_exp_f32 v53, v53
    v_exp_f32 v54, v54
    v_exp_f32 v55, v55
    v_mfma_f32_32x32x16_bf16 v[28:43], v[100:103], v[8:11], v[28:43]
    v_exp_f32 v56, v56
    v_exp_f32 v57, v57
    v_exp_f32 v58, v58
    v_exp_f32 v59, v59
    v_mfma_f32_32x32x16_bf16 v[76:91], v[112:115], v[64:67], v[76:91]
    ds_read_b128 v[96:99], v124 offset:31744
    ds_read_b64 v[104:105], v127 offset:30976
    s_mov_b64 exec, s[34:35]
    ds_read_b128 v[108:111], v130 offset:30720
    ds_read_b128 v[112:115], v130 offset:31360
    s_mov_b64 exec, -1
    s_add_u32 m0, s32, 65536
    s_add_u32 s33, s31, 65536
    buffer_load_dwordx4 v136, s[44:47], s33 offen lds
    v_cvt_pk_bf16_f32 v68, v44, v45
    v_cvt_pk_bf16_f32 v69, v46, v47
    v_cvt_pk_bf16_f32 v70, v48, v49
    v_cvt_pk_bf16_f32 v71, v50, v51
    v_cvt_pk_bf16_f32 v72, v52, v53
    v_cvt_pk_bf16_f32 v73, v54, v55
    v_cvt_pk_bf16_f32 v74, v56, v57
    v_cvt_pk_bf16_f32 v75, v58, v59
    s_waitcnt lgkmcnt(4)
    s_nop 0
    s_waitcnt lgkmcnt(2)
    v_exp_f32 v28, v28
    v_exp_f32 v29, v29
    v_exp_f32 v30, v30
    v_exp_f32 v31, v31
    v_mfma_f32_32x32x16_bf16 v[44:59], v[96:99], v[4:7], v[12:27]
    v_exp_f32 v32, v32
    v_exp_f32 v33, v33
    v_exp_f32 v34, v34
    v_exp_f32 v35, v35
    v_mfma_f32_32x32x16_bf16 v[76:91], v[116:119], v[68:71], v[76:91]
    v_exp_f32 v36, v36
    v_exp_f32 v37, v37
    v_exp_f32 v38, v38
    v_exp_f32 v39, v39
    v_mfma_f32_32x32x16_bf16 v[44:59], v[104:107], v[8:11], v[44:59]
    v_exp_f32 v40, v40
    v_exp_f32 v41, v41
    v_exp_f32 v42, v42
    v_exp_f32 v43, v43
    v_mfma_f32_32x32x16_bf16 v[76:91], v[120:123], v[72:75], v[76:91]
    ds_read_b128 v[92:95], v124 offset:35840
    ds_read_b64 v[100:101], v127 offset:35840
    s_mov_b64 exec, s[34:35]
    ds_read_b128 v[116:119], v130 offset:32000
    ds_read_b128 v[120:123], v130 offset:32640
    s_mov_b64 exec, -1
    v_cvt_pk_bf16_f32 v60, v28, v29
    v_cvt_pk_bf16_f32 v61, v30, v31
    v_cvt_pk_bf16_f32 v62, v32, v33
    v_cvt_pk_bf16_f32 v63, v34, v35
    v_cvt_pk_bf16_f32 v64, v36, v37
    v_cvt_pk_bf16_f32 v65, v38, v39
    v_cvt_pk_bf16_f32 v66, v40, v41
    v_cvt_pk_bf16_f32 v67, v42, v43
    s_waitcnt lgkmcnt(4)
    s_nop 0
    s_waitcnt lgkmcnt(2)
    v_exp_f32 v44, v44
    v_exp_f32 v45, v45
    v_exp_f32 v46, v46
    v_exp_f32 v47, v47
    v_mfma_f32_32x32x16_bf16 v[28:43], v[92:95], v[4:7], v[12:27]
    v_exp_f32 v48, v48
    v_exp_f32 v49, v49
    v_exp_f32 v50, v50
    v_exp_f32 v51, v51
    v_mfma_f32_32x32x16_bf16 v[76:91], v[108:111], v[60:63], v[76:91]
    v_exp_f32 v52, v52
    v_exp_f32 v53, v53
    v_exp_f32 v54, v54
    v_exp_f32 v55, v55
    v_mfma_f32_32x32x16_bf16 v[28:43], v[100:103], v[8:11], v[28:43]
    v_exp_f32 v56, v56
    v_exp_f32 v57, v57
    v_exp_f32 v58, v58
    v_exp_f32 v59, v59
    v_mfma_f32_32x32x16_bf16 v[76:91], v[112:115], v[64:67], v[76:91]
    ds_read_b128 v[96:99], v124 offset:36864
    ds_read_b64 v[104:105], v127 offset:36096
    s_mov_b64 exec, s[34:35]
    ds_read_b128 v[108:111], v130 offset:35840
    ds_read_b128 v[112:115], v130 offset:36480
    s_mov_b64 exec, -1
    s_add_u32 m0, s32, 73728
    s_add_u32 s33, s31, 73728
    buffer_load_dwordx4 v136, s[44:47], s33 offen lds
    v_cvt_pk_bf16_f32 v68, v44, v45
    v_cvt_pk_bf16_f32 v69, v46, v47
    v_cvt_pk_bf16_f32 v70, v48, v49
    v_cvt_pk_bf16_f32 v71, v50, v51
    v_cvt_pk_bf16_f32 v72, v52, v53
    v_cvt_pk_bf16_f32 v73, v54, v55
    v_cvt_pk_bf16_f32 v74, v56, v57
    v_cvt_pk_bf16_f32 v75, v58, v59
    s_waitcnt lgkmcnt(4)
    s_nop 0
    s_waitcnt lgkmcnt(2)
    v_exp_f32 v28, v28
    v_exp_f32 v29, v29
    v_exp_f32 v30, v30
    v_exp_f32 v31, v31
    v_mfma_f32_32x32x16_bf16 v[44:59], v[96:99], v[4:7], v[12:27]
    v_exp_f32 v32, v32
    v_exp_f32 v33, v33
    v_exp_f32 v34, v34
    v_exp_f32 v35, v35
    v_mfma_f32_32x32x16_bf16 v[76:91], v[116:119], v[68:71], v[76:91]
    v_exp_f32 v36, v36
    v_exp_f32 v37, v37
    v_exp_f32 v38, v38
    v_exp_f32 v39, v39
    v_mfma_f32_32x32x16_bf16 v[44:59], v[104:107], v[8:11], v[44:59]
    v_exp_f32 v40, v40
    v_exp_f32 v41, v41
    v_exp_f32 v42, v42
    v_exp_f32 v43, v43
    v_mfma_f32_32x32x16_bf16 v[76:91], v[120:123], v[72:75], v[76:91]
    s_waitcnt vmcnt(3)
    s_barrier
    ds_read_b128 v[92:95], v124 offset:40960
    ds_read_b64 v[100:101], v127 offset:40960
    s_mov_b64 exec, s[34:35]
    ds_read_b128 v[116:119], v130 offset:37120
    ds_read_b128 v[120:123], v130 offset:37760
    s_mov_b64 exec, -1
    v_cvt_pk_bf16_f32 v60, v28, v29
    v_cvt_pk_bf16_f32 v61, v30, v31
    v_cvt_pk_bf16_f32 v62, v32, v33
    v_cvt_pk_bf16_f32 v63, v34, v35
    v_cvt_pk_bf16_f32 v64, v36, v37
    v_cvt_pk_bf16_f32 v65, v38, v39
    v_cvt_pk_bf16_f32 v66, v40, v41
    v_cvt_pk_bf16_f32 v67, v42, v43
    s_waitcnt lgkmcnt(4)
    s_nop 0
    s_waitcnt lgkmcnt(2)
    v_exp_f32 v44, v44
    v_exp_f32 v45, v45
    v_exp_f32 v46, v46
    v_exp_f32 v47, v47
    v_mfma_f32_32x32x16_bf16 v[28:43], v[92:95], v[4:7], v[12:27]
    v_exp_f32 v48, v48
    v_exp_f32 v49, v49
    v_exp_f32 v50, v50
    v_exp_f32 v51, v51
    v_mfma_f32_32x32x16_bf16 v[76:91], v[108:111], v[60:63], v[76:91]
    v_exp_f32 v52, v52
    v_exp_f32 v53, v53
    v_exp_f32 v54, v54
    v_exp_f32 v55, v55
    v_mfma_f32_32x32x16_bf16 v[28:43], v[100:103], v[8:11], v[28:43]
    v_exp_f32 v56, v56
    v_exp_f32 v57, v57
    v_exp_f32 v58, v58
    v_exp_f32 v59, v59
    v_mfma_f32_32x32x16_bf16 v[76:91], v[112:115], v[64:67], v[76:91]
    ds_read_b128 v[96:99], v124 offset:41984
    ds_read_b64 v[104:105], v127 offset:41216
    s_mov_b64 exec, s[34:35]
    ds_read_b128 v[108:111], v130 offset:40960
    ds_read_b128 v[112:115], v130 offset:41600
    s_mov_b64 exec, -1
    s_add_u32 m0, s32, 81920
    s_add_u32 s33, s31, 81920
    buffer_load_dwordx4 v136, s[44:47], s33 offen lds
    v_cvt_pk_bf16_f32 v68, v44, v45
    v_cvt_pk_bf16_f32 v69, v46, v47
    v_cvt_pk_bf16_f32 v70, v48, v49
    v_cvt_pk_bf16_f32 v71, v50, v51
    v_cvt_pk_bf16_f32 v72, v52, v53
    v_cvt_pk_bf16_f32 v73, v54, v55
    v_cvt_pk_bf16_f32 v74, v56, v57
    v_cvt_pk_bf16_f32 v75, v58, v59
    s_waitcnt lgkmcnt(4)
    s_nop 0
    s_waitcnt lgkmcnt(2)
    v_exp_f32 v28, v28
    v_exp_f32 v29, v29
    v_exp_f32 v30, v30
    v_exp_f32 v31, v31
    v_mfma_f32_32x32x16_bf16 v[44:59], v[96:99], v[4:7], v[12:27]
    v_exp_f32 v32, v32
    v_exp_f32 v33, v33
    v_exp_f32 v34, v34
    v_exp_f32 v35, v35
    v_mfma_f32_32x32x16_bf16 v[76:91], v[116:119], v[68:71], v[76:91]
    v_exp_f32 v36, v36
    v_exp_f32 v37, v37
    v_exp_f32 v38, v38
    v_exp_f32 v39, v39
    v_mfma_f32_32x32x16_bf16 v[44:59], v[104:107], v[8:11], v[44:59]
    v_exp_f32 v40, v40
    v_exp_f32 v41, v41
    v_exp_f32 v42, v42
    v_exp_f32 v43, v43
    v_mfma_f32_32x32x16_bf16 v[76:91], v[120:123], v[72:75], v[76:91]
    ds_read_b128 v[92:95], v124 offset:46080
    ds_read_b64 v[100:101], v127 offset:46080
    s_mov_b64 exec, s[34:35]
    ds_read_b128 v[116:119], v130 offset:42240
    ds_read_b128 v[120:123], v130 offset:42880
    s_mov_b64 exec, -1
    v_cvt_pk_bf16_f32 v60, v28, v29
    v_cvt_pk_bf16_f32 v61, v30, v31
    v_cvt_pk_bf16_f32 v62, v32, v33
    v_cvt_pk_bf16_f32 v63, v34, v35
    v_cvt_pk_bf16_f32 v64, v36, v37
    v_cvt_pk_bf16_f32 v65, v38, v39
    v_cvt_pk_bf16_f32 v66, v40, v41
    v_cvt_pk_bf16_f32 v67, v42, v43
    s_waitcnt lgkmcnt(4)
    s_nop 0
    s_waitcnt lgkmcnt(2)
    v_exp_f32 v44, v44
    v_exp_f32 v45, v45
    v_exp_f32 v46, v46
    v_exp_f32 v47, v47
    v_mfma_f32_32x32x16_bf16 v[28:43], v[92:95], v[4:7], v[12:27]
    v_exp_f32 v48, v48
    v_exp_f32 v49, v49
    v_exp_f32 v50, v50
    v_exp_f32 v51, v51
    v_mfma_f32_32x32x16_bf16 v[76:91], v[108:111], v[60:63], v[76:91]
    v_exp_f32 v52, v52
    v_exp_f32 v53, v53
    v_exp_f32 v54, v54
    v_exp_f32 v55, v55
    v_mfma_f32_32x32x16_bf16 v[28:43], v[100:103], v[8:11], v[28:43]
    v_exp_f32 v56, v56
    v_exp_f32 v57, v57
    v_exp_f32 v58, v58
    v_exp_f32 v59, v59
    v_mfma_f32_32x32x16_bf16 v[76:91], v[112:115], v[64:67], v[76:91]
    ds_read_b128 v[96:99], v124 offset:47104
    ds_read_b64 v[104:105], v127 offset:46336
    s_mov_b64 exec, s[34:35]
    ds_read_b128 v[108:111], v130 offset:46080
    ds_read_b128 v[112:115], v130 offset:46720
    s_mov_b64 exec, -1
    s_add_u32 m0, s32, 90112
    s_add_u32 s33, s31, 90112
    buffer_load_dwordx4 v136, s[44:47], s33 offen lds
    v_cvt_pk_bf16_f32 v68, v44, v45
    v_cvt_pk_bf16_f32 v69, v46, v47
    v_cvt_pk_bf16_f32 v70, v48, v49
    v_cvt_pk_bf16_f32 v71, v50, v51
    v_cvt_pk_bf16_f32 v72, v52, v53
    v_cvt_pk_bf16_f32 v73, v54, v55
    v_cvt_pk_bf16_f32 v74, v56, v57
    v_cvt_pk_bf16_f32 v75, v58, v59
    s_waitcnt lgkmcnt(4)
    s_nop 0
    s_waitcnt lgkmcnt(2)
    v_exp_f32 v28, v28
    v_exp_f32 v29, v29
    v_exp_f32 v30, v30
    v_exp_f32 v31, v31
    v_mfma_f32_32x32x16_bf16 v[44:59], v[96:99], v[4:7], v[12:27]
    v_exp_f32 v32, v32
    v_exp_f32 v33, v33
    v_exp_f32 v34, v34
    v_exp_f32 v35, v35
    v_mfma_f32_32x32x16_bf16 v[76:91], v[116:119], v[68:71], v[76:91]
    v_exp_f32 v36, v36
    v_exp_f32 v37, v37
    v_exp_f32 v38, v38
    v_exp_f32 v39, v39
    v_mfma_f32_32x32x16_bf16 v[44:59], v[104:107], v[8:11], v[44:59]
    v_exp_f32 v40, v40
    v_exp_f32 v41, v41
    v_exp_f32 v42, v42
    v_exp_f32 v43, v43
    v_mfma_f32_32x32x16_bf16 v[76:91], v[120:123], v[72:75], v[76:91]
    s_waitcnt vmcnt(4)
    s_barrier
    ds_read_b128 v[92:95], v124 offset:51200
    ds_read_b64 v[100:101], v127 offset:51200
    s_mov_b64 exec, s[34:35]
    ds_read_b128 v[116:119], v130 offset:47360
    ds_read_b128 v[120:123], v130 offset:48000
    s_mov_b64 exec, -1
    v_cvt_pk_bf16_f32 v60, v28, v29
    v_cvt_pk_bf16_f32 v61, v30, v31
    v_cvt_pk_bf16_f32 v62, v32, v33
    v_cvt_pk_bf16_f32 v63, v34, v35
    v_cvt_pk_bf16_f32 v64, v36, v37
    v_cvt_pk_bf16_f32 v65, v38, v39
    v_cvt_pk_bf16_f32 v66, v40, v41
    v_cvt_pk_bf16_f32 v67, v42, v43
    s_waitcnt lgkmcnt(4)
    s_nop 0
    s_waitcnt lgkmcnt(2)
    v_exp_f32 v44, v44
    v_exp_f32 v45, v45
    v_exp_f32 v46, v46
    v_exp_f32 v47, v47
    v_mfma_f32_32x32x16_bf16 v[28:43], v[92:95], v[4:7], v[12:27]
    v_exp_f32 v48, v48
    v_exp_f32 v49, v49
    v_exp_f32 v50, v50
    v_exp_f32 v51, v51
    v_mfma_f32_32x32x16_bf16 v[76:91], v[108:111], v[60:63], v[76:91]
    v_exp_f32 v52, v52
    v_exp_f32 v53, v53
    v_exp_f32 v54, v54
    v_exp_f32 v55, v55
    v_mfma_f32_32x32x16_bf16 v[28:43], v[100:103], v[8:11], v[28:43]
    v_exp_f32 v56, v56
    v_exp_f32 v57, v57
    v_exp_f32 v58, v58
    v_exp_f32 v59, v59
    v_mfma_f32_32x32x16_bf16 v[76:91], v[112:115], v[64:67], v[76:91]
    ds_read_b128 v[96:99], v124 offset:52224
    ds_read_b64 v[104:105], v127 offset:51456
    s_mov_b64 exec, s[34:35]
    ds_read_b128 v[108:111], v130 offset:51200
    ds_read_b128 v[112:115], v130 offset:51840
    s_mov_b64 exec, -1
    s_add_u32 m0, s32, 98304
    s_add_u32 s33, s31, 98304
    buffer_load_dwordx4 v136, s[44:47], s33 offen lds
    v_cvt_pk_bf16_f32 v68, v44, v45
    v_cvt_pk_bf16_f32 v69, v46, v47
    v_cvt_pk_bf16_f32 v70, v48, v49
    v_cvt_pk_bf16_f32 v71, v50, v51
    v_cvt_pk_bf16_f32 v72, v52, v53
    v_cvt_pk_bf16_f32 v73, v54, v55
    v_cvt_pk_bf16_f32 v74, v56, v57
    v_cvt_pk_bf16_f32 v75, v58, v59
    s_waitcnt lgkmcnt(4)
    s_nop 0
    s_waitcnt lgkmcnt(2)
    v_exp_f32 v28, v28
    v_exp_f32 v29, v29
    v_exp_f32 v30, v30
    v_exp_f32 v31, v31
    v_mfma_f32_32x32x16_bf16 v[44:59], v[96:99], v[4:7], v[12:27]
    v_exp_f32 v32, v32
    v_exp_f32 v33, v33
    v_exp_f32 v34, v34
    v_exp_f32 v35, v35
    v_mfma_f32_32x32x16_bf16 v[76:91], v[116:119], v[68:71], v[76:91]
    v_exp_f32 v36, v36
    v_exp_f32 v37, v37
    v_exp_f32 v38, v38
    v_exp_f32 v39, v39
    v_mfma_f32_32x32x16_bf16 v[44:59], v[104:107], v[8:11], v[44:59]
    v_exp_f32 v40, v40
    v_exp_f32 v41, v41
    v_exp_f32 v42, v42
    v_exp_f32 v43, v43
    v_mfma_f32_32x32x16_bf16 v[76:91], v[120:123], v[72:75], v[76:91]
    ds_read_b128 v[92:95], v124 offset:56320
    ds_read_b64 v[100:101], v127 offset:56320
    s_mov_b64 exec, s[34:35]
    ds_read_b128 v[116:119], v130 offset:52480
    ds_read_b128 v[120:123], v130 offset:53120
    s_mov_b64 exec, -1
    v_cvt_pk_bf16_f32 v60, v28, v29
    v_cvt_pk_bf16_f32 v61, v30, v31
    v_cvt_pk_bf16_f32 v62, v32, v33
    v_cvt_pk_bf16_f32 v63, v34, v35
    v_cvt_pk_bf16_f32 v64, v36, v37
    v_cvt_pk_bf16_f32 v65, v38, v39
    v_cvt_pk_bf16_f32 v66, v40, v41
    v_cvt_pk_bf16_f32 v67, v42, v43
    s_waitcnt lgkmcnt(4)
    s_nop 0
    s_waitcnt lgkmcnt(2)
    v_exp_f32 v44, v44
    v_exp_f32 v45, v45
    v_exp_f32 v46, v46
    v_exp_f32 v47, v47
    v_mfma_f32_32x32x16_bf16 v[28:43], v[92:95], v[4:7], v[12:27]
    v_exp_f32 v48, v48
    v_exp_f32 v49, v49
    v_exp_f32 v50, v50
    v_exp_f32 v51, v51
    v_mfma_f32_32x32x16_bf16 v[76:91], v[108:111], v[60:63], v[76:91]
    v_exp_f32 v52, v52
    v_exp_f32 v53, v53
    v_exp_f32 v54, v54
    v_exp_f32 v55, v55
    v_mfma_f32_32x32x16_bf16 v[28:43], v[100:103], v[8:11], v[28:43]
    v_exp_f32 v56, v56
    v_exp_f32 v57, v57
    v_exp_f32 v58, v58
    v_exp_f32 v59, v59
    v_mfma_f32_32x32x16_bf16 v[76:91], v[112:115], v[64:67], v[76:91]
    ds_read_b128 v[96:99], v124 offset:57344
    ds_read_b64 v[104:105], v127 offset:56576
    s_mov_b64 exec, s[34:35]
    ds_read_b128 v[108:111], v130 offset:56320
    ds_read_b128 v[112:115], v130 offset:56960
    s_mov_b64 exec, -1
    s_add_u32 m0, s32, 106496
    s_add_u32 s33, s31, 106496
    buffer_load_dwordx4 v136, s[44:47], s33 offen lds
    v_cvt_pk_bf16_f32 v68, v44, v45
    v_cvt_pk_bf16_f32 v69, v46, v47
    v_cvt_pk_bf16_f32 v70, v48, v49
    v_cvt_pk_bf16_f32 v71, v50, v51
    v_cvt_pk_bf16_f32 v72, v52, v53
    v_cvt_pk_bf16_f32 v73, v54, v55
    v_cvt_pk_bf16_f32 v74, v56, v57
    v_cvt_pk_bf16_f32 v75, v58, v59
    s_waitcnt lgkmcnt(4)
    s_nop 0
    s_waitcnt lgkmcnt(2)
    v_exp_f32 v28, v28
    v_exp_f32 v29, v29
    v_exp_f32 v30, v30
    v_exp_f32 v31, v31
    v_mfma_f32_32x32x16_bf16 v[44:59], v[96:99], v[4:7], v[12:27]
    v_exp_f32 v32, v32
    v_exp_f32 v33, v33
    v_exp_f32 v34, v34
    v_exp_f32 v35, v35
    v_mfma_f32_32x32x16_bf16 v[76:91], v[116:119], v[68:71], v[76:91]
    v_exp_f32 v36, v36
    v_exp_f32 v37, v37
    v_exp_f32 v38, v38
    v_exp_f32 v39, v39
    v_mfma_f32_32x32x16_bf16 v[44:59], v[104:107], v[8:11], v[44:59]
    v_exp_f32 v40, v40
    v_exp_f32 v41, v41
    v_exp_f32 v42, v42
    v_exp_f32 v43, v43
    v_mfma_f32_32x32x16_bf16 v[76:91], v[120:123], v[72:75], v[76:91]
    s_waitcnt vmcnt(5)
    s_barrier
    ds_read_b128 v[92:95], v125
    ds_read_b64 v[100:101], v128
    s_mov_b64 exec, s[34:35]
    ds_read_b128 v[116:119], v130 offset:57600
    ds_read_b128 v[120:123], v130 offset:58240
    s_mov_b64 exec, -1
    v_cvt_pk_bf16_f32 v60, v28, v29
    v_cvt_pk_bf16_f32 v61, v30, v31
    v_cvt_pk_bf16_f32 v62, v32, v33
    v_cvt_pk_bf16_f32 v63, v34, v35
    v_cvt_pk_bf16_f32 v64, v36, v37
    v_cvt_pk_bf16_f32 v65, v38, v39
    v_cvt_pk_bf16_f32 v66, v40, v41
    v_cvt_pk_bf16_f32 v67, v42, v43
    s_waitcnt lgkmcnt(4)
    s_nop 0
    s_waitcnt lgkmcnt(2)
    v_exp_f32 v44, v44
    v_exp_f32 v45, v45
    v_exp_f32 v46, v46
    v_exp_f32 v47, v47
    v_mfma_f32_32x32x16_bf16 v[28:43], v[92:95], v[4:7], v[12:27]
    v_exp_f32 v48, v48
    v_exp_f32 v49, v49
    v_exp_f32 v50, v50
    v_exp_f32 v51, v51
    v_mfma_f32_32x32x16_bf16 v[76:91], v[108:111], v[60:63], v[76:91]
    v_exp_f32 v52, v52
    v_exp_f32 v53, v53
    v_exp_f32 v54, v54
    v_exp_f32 v55, v55
    v_mfma_f32_32x32x16_bf16 v[28:43], v[100:103], v[8:11], v[28:43]
    v_exp_f32 v56, v56
    v_exp_f32 v57, v57
    v_exp_f32 v58, v58
    v_exp_f32 v59, v59
    v_mfma_f32_32x32x16_bf16 v[76:91], v[112:115], v[64:67], v[76:91]
    ds_read_b128 v[96:99], v125 offset:1024
    ds_read_b64 v[104:105], v128 offset:256
    s_mov_b64 exec, s[34:35]
    ds_read_b128 v[108:111], v131
    ds_read_b128 v[112:115], v131 offset:640
    s_mov_b64 exec, -1
    s_add_u32 m0, s32, 114688
    s_add_u32 s33, s31, 114688
    buffer_load_dwordx4 v136, s[44:47], s33 offen lds
    v_cvt_pk_bf16_f32 v68, v44, v45
    v_cvt_pk_bf16_f32 v69, v46, v47
    v_cvt_pk_bf16_f32 v70, v48, v49
    v_cvt_pk_bf16_f32 v71, v50, v51
    v_cvt_pk_bf16_f32 v72, v52, v53
    v_cvt_pk_bf16_f32 v73, v54, v55
    v_cvt_pk_bf16_f32 v74, v56, v57
    v_cvt_pk_bf16_f32 v75, v58, v59
    s_waitcnt lgkmcnt(4)
    s_nop 0
    s_waitcnt lgkmcnt(2)
    v_exp_f32 v28, v28
    v_exp_f32 v29, v29
    v_exp_f32 v30, v30
    v_exp_f32 v31, v31
    v_mfma_f32_32x32x16_bf16 v[44:59], v[96:99], v[4:7], v[12:27]
    v_exp_f32 v32, v32
    v_exp_f32 v33, v33
    v_exp_f32 v34, v34
    v_exp_f32 v35, v35
    v_mfma_f32_32x32x16_bf16 v[76:91], v[116:119], v[68:71], v[76:91]
    v_exp_f32 v36, v36
    v_exp_f32 v37, v37
    v_exp_f32 v38, v38
    v_exp_f32 v39, v39
    v_mfma_f32_32x32x16_bf16 v[44:59], v[104:107], v[8:11], v[44:59]
    v_exp_f32 v40, v40
    v_exp_f32 v41, v41
    v_exp_f32 v42, v42
    v_exp_f32 v43, v43
    v_mfma_f32_32x32x16_bf16 v[76:91], v[120:123], v[72:75], v[76:91]
    ds_read_b128 v[92:95], v125 offset:5120
    ds_read_b64 v[100:101], v128 offset:5120
    s_mov_b64 exec, s[34:35]
    ds_read_b128 v[116:119], v131 offset:1280
    ds_read_b128 v[120:123], v131 offset:1920
    s_mov_b64 exec, -1
    v_cvt_pk_bf16_f32 v60, v28, v29
    v_cvt_pk_bf16_f32 v61, v30, v31
    v_cvt_pk_bf16_f32 v62, v32, v33
    v_cvt_pk_bf16_f32 v63, v34, v35
    v_cvt_pk_bf16_f32 v64, v36, v37
    v_cvt_pk_bf16_f32 v65, v38, v39
    v_cvt_pk_bf16_f32 v66, v40, v41
    v_cvt_pk_bf16_f32 v67, v42, v43
    s_waitcnt lgkmcnt(4)
    s_nop 0
    s_waitcnt lgkmcnt(2)
    v_exp_f32 v44, v44
    v_exp_f32 v45, v45
    v_exp_f32 v46, v46
    v_exp_f32 v47, v47
    v_mfma_f32_32x32x16_bf16 v[28:43], v[92:95], v[4:7], v[12:27]
    v_exp_f32 v48, v48
    v_exp_f32 v49, v49
    v_exp_f32 v50, v50
    v_exp_f32 v51, v51
    v_mfma_f32_32x32x16_bf16 v[76:91], v[108:111], v[60:63], v[76:91]
    v_exp_f32 v52, v52
    v_exp_f32 v53, v53
    v_exp_f32 v54, v54
    v_exp_f32 v55, v55
    v_mfma_f32_32x32x16_bf16 v[28:43], v[100:103], v[8:11], v[28:43]
    v_exp_f32 v56, v56
    v_exp_f32 v57, v57
    v_exp_f32 v58, v58
    v_exp_f32 v59, v59
    v_mfma_f32_32x32x16_bf16 v[76:91], v[112:115], v[64:67], v[76:91]
    ds_read_b128 v[96:99], v125 offset:6144
    ds_read_b64 v[104:105], v128 offset:5376
    s_mov_b64 exec, s[34:35]
    ds_read_b128 v[108:111], v131 offset:5120
    ds_read_b128 v[112:115], v131 offset:5760
    s_mov_b64 exec, -1
    s_add_u32 m0, s32, 122880
    s_add_u32 s33, s31, 122880
    buffer_load_dwordx4 v136, s[44:47], s33 offen lds
    v_cvt_pk_bf16_f32 v68, v44, v45
    v_cvt_pk_bf16_f32 v69, v46, v47
    v_cvt_pk_bf16_f32 v70, v48, v49
    v_cvt_pk_bf16_f32 v71, v50, v51
    v_cvt_pk_bf16_f32 v72, v52, v53
    v_cvt_pk_bf16_f32 v73, v54, v55
    v_cvt_pk_bf16_f32 v74, v56, v57
    v_cvt_pk_bf16_f32 v75, v58, v59
    s_waitcnt lgkmcnt(4)
    s_nop 0
    s_waitcnt lgkmcnt(2)
    v_exp_f32 v28, v28
    v_exp_f32 v29, v29
    v_exp_f32 v30, v30
    v_exp_f32 v31, v31
    v_mfma_f32_32x32x16_bf16 v[44:59], v[96:99], v[4:7], v[12:27]
    v_exp_f32 v32, v32
    v_exp_f32 v33, v33
    v_exp_f32 v34, v34
    v_exp_f32 v35, v35
    v_mfma_f32_32x32x16_bf16 v[76:91], v[116:119], v[68:71], v[76:91]
    v_exp_f32 v36, v36
    v_exp_f32 v37, v37
    v_exp_f32 v38, v38
    v_exp_f32 v39, v39
    v_mfma_f32_32x32x16_bf16 v[44:59], v[104:107], v[8:11], v[44:59]
    v_exp_f32 v40, v40
    v_exp_f32 v41, v41
    v_exp_f32 v42, v42
    v_exp_f32 v43, v43
    v_mfma_f32_32x32x16_bf16 v[76:91], v[120:123], v[72:75], v[76:91]
    s_waitcnt vmcnt(6)
    s_barrier
    ds_read_b128 v[92:95], v125 offset:10240
    ds_read_b64 v[100:101], v128 offset:10240
    s_mov_b64 exec, s[34:35]
    ds_read_b128 v[116:119], v131 offset:6400
    ds_read_b128 v[120:123], v131 offset:7040
    s_mov_b64 exec, -1
    v_cvt_pk_bf16_f32 v60, v28, v29
    v_cvt_pk_bf16_f32 v61, v30, v31
    v_cvt_pk_bf16_f32 v62, v32, v33
    v_cvt_pk_bf16_f32 v63, v34, v35
    v_cvt_pk_bf16_f32 v64, v36, v37
    v_cvt_pk_bf16_f32 v65, v38, v39
    v_cvt_pk_bf16_f32 v66, v40, v41
    v_cvt_pk_bf16_f32 v67, v42, v43
    s_waitcnt lgkmcnt(4)
    s_nop 0
    s_waitcnt lgkmcnt(2)
    v_exp_f32 v44, v44
    v_exp_f32 v45, v45
    v_exp_f32 v46, v46
    v_exp_f32 v47, v47
    v_mfma_f32_32x32x16_bf16 v[28:43], v[92:95], v[4:7], v[12:27]
    v_exp_f32 v48, v48
    v_exp_f32 v49, v49
    v_exp_f32 v50, v50
    v_exp_f32 v51, v51
    v_mfma_f32_32x32x16_bf16 v[76:91], v[108:111], v[60:63], v[76:91]
    v_exp_f32 v52, v52
    v_exp_f32 v53, v53
    v_exp_f32 v54, v54
    v_exp_f32 v55, v55
    v_mfma_f32_32x32x16_bf16 v[28:43], v[100:103], v[8:11], v[28:43]
    v_exp_f32 v56, v56
    v_exp_f32 v57, v57
    v_exp_f32 v58, v58
    v_exp_f32 v59, v59
    v_mfma_f32_32x32x16_bf16 v[76:91], v[112:115], v[64:67], v[76:91]
    ds_read_b128 v[96:99], v125 offset:11264
    ds_read_b64 v[104:105], v128 offset:10496
    s_mov_b64 exec, s[34:35]
    ds_read_b128 v[108:111], v131 offset:10240
    ds_read_b128 v[112:115], v131 offset:10880
    s_mov_b64 exec, -1
    s_add_u32 m0, s32, 131072
    s_add_u32 s33, s31, 131072
    buffer_load_dwordx4 v136, s[44:47], s33 offen lds
    v_cvt_pk_bf16_f32 v68, v44, v45
    v_cvt_pk_bf16_f32 v69, v46, v47
    v_cvt_pk_bf16_f32 v70, v48, v49
    v_cvt_pk_bf16_f32 v71, v50, v51
    v_cvt_pk_bf16_f32 v72, v52, v53
    v_cvt_pk_bf16_f32 v73, v54, v55
    v_cvt_pk_bf16_f32 v74, v56, v57
    v_cvt_pk_bf16_f32 v75, v58, v59
    s_waitcnt lgkmcnt(4)
    s_nop 0
    s_waitcnt lgkmcnt(2)
    v_exp_f32 v28, v28
    v_exp_f32 v29, v29
    v_exp_f32 v30, v30
    v_exp_f32 v31, v31
    v_mfma_f32_32x32x16_bf16 v[44:59], v[96:99], v[4:7], v[12:27]
    v_exp_f32 v32, v32
    v_exp_f32 v33, v33
    v_exp_f32 v34, v34
    v_exp_f32 v35, v35
    v_mfma_f32_32x32x16_bf16 v[76:91], v[116:119], v[68:71], v[76:91]
    v_exp_f32 v36, v36
    v_exp_f32 v37, v37
    v_exp_f32 v38, v38
    v_exp_f32 v39, v39
    v_mfma_f32_32x32x16_bf16 v[44:59], v[104:107], v[8:11], v[44:59]
    v_exp_f32 v40, v40
    v_exp_f32 v41, v41
    v_exp_f32 v42, v42
    v_exp_f32 v43, v43
    v_mfma_f32_32x32x16_bf16 v[76:91], v[120:123], v[72:75], v[76:91]
    ds_read_b128 v[92:95], v125 offset:15360
    ds_read_b64 v[100:101], v128 offset:15360
    s_mov_b64 exec, s[34:35]
    ds_read_b128 v[116:119], v131 offset:11520
    ds_read_b128 v[120:123], v131 offset:12160
    s_mov_b64 exec, -1
    v_cvt_pk_bf16_f32 v60, v28, v29
    v_cvt_pk_bf16_f32 v61, v30, v31
    v_cvt_pk_bf16_f32 v62, v32, v33
    v_cvt_pk_bf16_f32 v63, v34, v35
    v_cvt_pk_bf16_f32 v64, v36, v37
    v_cvt_pk_bf16_f32 v65, v38, v39
    v_cvt_pk_bf16_f32 v66, v40, v41
    v_cvt_pk_bf16_f32 v67, v42, v43
    s_waitcnt lgkmcnt(4)
    s_nop 0
    s_waitcnt lgkmcnt(2)
    v_exp_f32 v44, v44
    v_exp_f32 v45, v45
    v_exp_f32 v46, v46
    v_exp_f32 v47, v47
    v_mfma_f32_32x32x16_bf16 v[28:43], v[92:95], v[4:7], v[12:27]
    v_exp_f32 v48, v48
    v_exp_f32 v49, v49
    v_exp_f32 v50, v50
    v_exp_f32 v51, v51
    v_mfma_f32_32x32x16_bf16 v[76:91], v[108:111], v[60:63], v[76:91]
    v_exp_f32 v52, v52
    v_exp_f32 v53, v53
    v_exp_f32 v54, v54
    v_exp_f32 v55, v55
    v_mfma_f32_32x32x16_bf16 v[28:43], v[100:103], v[8:11], v[28:43]
    v_exp_f32 v56, v56
    v_exp_f32 v57, v57
    v_exp_f32 v58, v58
    v_exp_f32 v59, v59
    v_mfma_f32_32x32x16_bf16 v[76:91], v[112:115], v[64:67], v[76:91]
    ds_read_b128 v[96:99], v125 offset:16384
    ds_read_b64 v[104:105], v128 offset:15616
    s_mov_b64 exec, s[34:35]
    ds_read_b128 v[108:111], v131 offset:15360
    ds_read_b128 v[112:115], v131 offset:16000
    s_mov_b64 exec, -1
    s_add_u32 m0, s32, 139264
    s_add_u32 s33, s31, 139264
    buffer_load_dwordx4 v136, s[44:47], s33 offen lds
    v_cvt_pk_bf16_f32 v68, v44, v45
    v_cvt_pk_bf16_f32 v69, v46, v47
    v_cvt_pk_bf16_f32 v70, v48, v49
    v_cvt_pk_bf16_f32 v71, v50, v51
    v_cvt_pk_bf16_f32 v72, v52, v53
    v_cvt_pk_bf16_f32 v73, v54, v55
    v_cvt_pk_bf16_f32 v74, v56, v57
    v_cvt_pk_bf16_f32 v75, v58, v59
    s_waitcnt lgkmcnt(4)
    s_nop 0
    s_waitcnt lgkmcnt(2)
    v_exp_f32 v28, v28
    v_exp_f32 v29, v29
    v_exp_f32 v30, v30
    v_exp_f32 v31, v31
    v_mfma_f32_32x32x16_bf16 v[44:59], v[96:99], v[4:7], v[12:27]
    v_exp_f32 v32, v32
    v_exp_f32 v33, v33
    v_exp_f32 v34, v34
    v_exp_f32 v35, v35
    v_mfma_f32_32x32x16_bf16 v[76:91], v[116:119], v[68:71], v[76:91]
    v_exp_f32 v36, v36
    v_exp_f32 v37, v37
    v_exp_f32 v38, v38
    v_exp_f32 v39, v39
    v_mfma_f32_32x32x16_bf16 v[44:59], v[104:107], v[8:11], v[44:59]
    v_exp_f32 v40, v40
    v_exp_f32 v41, v41
    v_exp_f32 v42, v42
    v_exp_f32 v43, v43
    v_mfma_f32_32x32x16_bf16 v[76:91], v[120:123], v[72:75], v[76:91]
    s_waitcnt vmcnt(6)
    s_barrier
    ds_read_b128 v[92:95], v125 offset:20480
    ds_read_b64 v[100:101], v128 offset:20480
    s_mov_b64 exec, s[34:35]
    ds_read_b128 v[116:119], v131 offset:16640
    ds_read_b128 v[120:123], v131 offset:17280
    s_mov_b64 exec, -1
    v_cvt_pk_bf16_f32 v60, v28, v29
    v_cvt_pk_bf16_f32 v61, v30, v31
    v_cvt_pk_bf16_f32 v62, v32, v33
    v_cvt_pk_bf16_f32 v63, v34, v35
    v_cvt_pk_bf16_f32 v64, v36, v37
    v_cvt_pk_bf16_f32 v65, v38, v39
    v_cvt_pk_bf16_f32 v66, v40, v41
    v_cvt_pk_bf16_f32 v67, v42, v43
    s_waitcnt lgkmcnt(4)
    s_nop 0
    s_waitcnt lgkmcnt(2)
    v_exp_f32 v44, v44
    v_exp_f32 v45, v45
    v_exp_f32 v46, v46
    v_exp_f32 v47, v47
    v_mfma_f32_32x32x16_bf16 v[28:43], v[92:95], v[4:7], v[12:27]
    v_exp_f32 v48, v48
    v_exp_f32 v49, v49
    v_exp_f32 v50, v50
    v_exp_f32 v51, v51
    v_mfma_f32_32x32x16_bf16 v[76:91], v[108:111], v[60:63], v[76:91]
    v_exp_f32 v52, v52
    v_exp_f32 v53, v53
    v_exp_f32 v54, v54
    v_exp_f32 v55, v55
    v_mfma_f32_32x32x16_bf16 v[28:43], v[100:103], v[8:11], v[28:43]
    v_exp_f32 v56, v56
    v_exp_f32 v57, v57
    v_exp_f32 v58, v58
    v_exp_f32 v59, v59
    v_mfma_f32_32x32x16_bf16 v[76:91], v[112:115], v[64:67], v[76:91]
    ds_read_b128 v[96:99], v125 offset:21504
    ds_read_b64 v[104:105], v128 offset:20736
    s_mov_b64 exec, s[34:35]
    ds_read_b128 v[108:111], v131 offset:20480
    ds_read_b128 v[112:115], v131 offset:21120
    s_mov_b64 exec, -1
    s_add_u32 m0, s32, 147456
    s_add_u32 s33, s31, 147456
    buffer_load_dwordx4 v136, s[44:47], s33 offen lds
    v_cvt_pk_bf16_f32 v68, v44, v45
    v_cvt_pk_bf16_f32 v69, v46, v47
    v_cvt_pk_bf16_f32 v70, v48, v49
    v_cvt_pk_bf16_f32 v71, v50, v51
    v_cvt_pk_bf16_f32 v72, v52, v53
    v_cvt_pk_bf16_f32 v73, v54, v55
    v_cvt_pk_bf16_f32 v74, v56, v57
    v_cvt_pk_bf16_f32 v75, v58, v59
    s_waitcnt lgkmcnt(4)
    s_nop 0
    s_waitcnt lgkmcnt(2)
    v_exp_f32 v28, v28
    v_exp_f32 v29, v29
    v_exp_f32 v30, v30
    v_exp_f32 v31, v31
    v_mfma_f32_32x32x16_bf16 v[44:59], v[96:99], v[4:7], v[12:27]
    v_exp_f32 v32, v32
    v_exp_f32 v33, v33
    v_exp_f32 v34, v34
    v_exp_f32 v35, v35
    v_mfma_f32_32x32x16_bf16 v[76:91], v[116:119], v[68:71], v[76:91]
    v_exp_f32 v36, v36
    v_exp_f32 v37, v37
    v_exp_f32 v38, v38
    v_exp_f32 v39, v39
    v_mfma_f32_32x32x16_bf16 v[44:59], v[104:107], v[8:11], v[44:59]
    v_exp_f32 v40, v40
    v_exp_f32 v41, v41
    v_exp_f32 v42, v42
    v_exp_f32 v43, v43
    v_mfma_f32_32x32x16_bf16 v[76:91], v[120:123], v[72:75], v[76:91]
    ds_read_b128 v[92:95], v125 offset:25600
    ds_read_b64 v[100:101], v128 offset:25600
    s_mov_b64 exec, s[34:35]
    ds_read_b128 v[116:119], v131 offset:21760
    ds_read_b128 v[120:123], v131 offset:22400
    s_mov_b64 exec, -1
    v_cvt_pk_bf16_f32 v60, v28, v29
    v_cvt_pk_bf16_f32 v61, v30, v31
    v_cvt_pk_bf16_f32 v62, v32, v33
    v_cvt_pk_bf16_f32 v63, v34, v35
    v_cvt_pk_bf16_f32 v64, v36, v37
    v_cvt_pk_bf16_f32 v65, v38, v39
    v_cvt_pk_bf16_f32 v66, v40, v41
    v_cvt_pk_bf16_f32 v67, v42, v43
    s_waitcnt lgkmcnt(4)
    s_nop 0
    s_waitcnt lgkmcnt(2)
    v_exp_f32 v44, v44
    v_exp_f32 v45, v45
    v_exp_f32 v46, v46
    v_exp_f32 v47, v47
    v_mfma_f32_32x32x16_bf16 v[28:43], v[92:95], v[4:7], v[12:27]
    v_exp_f32 v48, v48
    v_exp_f32 v49, v49
    v_exp_f32 v50, v50
    v_exp_f32 v51, v51
    v_mfma_f32_32x32x16_bf16 v[76:91], v[108:111], v[60:63], v[76:91]
    v_exp_f32 v52, v52
    v_exp_f32 v53, v53
    v_exp_f32 v54, v54
    v_exp_f32 v55, v55
    v_mfma_f32_32x32x16_bf16 v[28:43], v[100:103], v[8:11], v[28:43]
    v_exp_f32 v56, v56
    v_exp_f32 v57, v57
    v_exp_f32 v58, v58
    v_exp_f32 v59, v59
    v_mfma_f32_32x32x16_bf16 v[76:91], v[112:115], v[64:67], v[76:91]
    ds_read_b128 v[96:99], v125 offset:26624
    ds_read_b64 v[104:105], v128 offset:25856
    s_mov_b64 exec, s[34:35]
    ds_read_b128 v[108:111], v131 offset:25600
    ds_read_b128 v[112:115], v131 offset:26240
    s_mov_b64 exec, -1
    s_add_u32 m0, s32, 155648
    s_add_u32 s33, s31, 155648
    buffer_load_dwordx4 v136, s[44:47], s33 offen lds
    v_cvt_pk_bf16_f32 v68, v44, v45
    v_cvt_pk_bf16_f32 v69, v46, v47
    v_cvt_pk_bf16_f32 v70, v48, v49
    v_cvt_pk_bf16_f32 v71, v50, v51
    v_cvt_pk_bf16_f32 v72, v52, v53
    v_cvt_pk_bf16_f32 v73, v54, v55
    v_cvt_pk_bf16_f32 v74, v56, v57
    v_cvt_pk_bf16_f32 v75, v58, v59
    s_waitcnt lgkmcnt(4)
    s_nop 0
    s_waitcnt lgkmcnt(2)
    v_exp_f32 v28, v28
    v_exp_f32 v29, v29
    v_exp_f32 v30, v30
    v_exp_f32 v31, v31
    v_mfma_f32_32x32x16_bf16 v[44:59], v[96:99], v[4:7], v[12:27]
    v_exp_f32 v32, v32
    v_exp_f32 v33, v33
    v_exp_f32 v34, v34
    v_exp_f32 v35, v35
    v_mfma_f32_32x32x16_bf16 v[76:91], v[116:119], v[68:71], v[76:91]
    v_exp_f32 v36, v36
    v_exp_f32 v37, v37
    v_exp_f32 v38, v38
    v_exp_f32 v39, v39
    v_mfma_f32_32x32x16_bf16 v[44:59], v[104:107], v[8:11], v[44:59]
    v_exp_f32 v40, v40
    v_exp_f32 v41, v41
    v_exp_f32 v42, v42
    v_exp_f32 v43, v43
    v_mfma_f32_32x32x16_bf16 v[76:91], v[120:123], v[72:75], v[76:91]
    s_waitcnt vmcnt(7)
    s_barrier
    ds_read_b128 v[92:95], v125 offset:30720
    ds_read_b64 v[100:101], v128 offset:30720
    s_mov_b64 exec, s[34:35]
    ds_read_b128 v[116:119], v131 offset:26880
    ds_read_b128 v[120:123], v131 offset:27520
    s_mov_b64 exec, -1
    v_cvt_pk_bf16_f32 v60, v28, v29
    v_cvt_pk_bf16_f32 v61, v30, v31
    v_cvt_pk_bf16_f32 v62, v32, v33
    v_cvt_pk_bf16_f32 v63, v34, v35
    v_cvt_pk_bf16_f32 v64, v36, v37
    v_cvt_pk_bf16_f32 v65, v38, v39
    v_cvt_pk_bf16_f32 v66, v40, v41
    v_cvt_pk_bf16_f32 v67, v42, v43
    s_waitcnt lgkmcnt(4)
    s_nop 0
    s_waitcnt lgkmcnt(2)
    v_exp_f32 v44, v44
    v_exp_f32 v45, v45
    v_exp_f32 v46, v46
    v_exp_f32 v47, v47
    v_mfma_f32_32x32x16_bf16 v[28:43], v[92:95], v[4:7], v[12:27]
    v_exp_f32 v48, v48
    v_exp_f32 v49, v49
    v_exp_f32 v50, v50
    v_exp_f32 v51, v51
    v_mfma_f32_32x32x16_bf16 v[76:91], v[108:111], v[60:63], v[76:91]
    v_exp_f32 v52, v52
    v_exp_f32 v53, v53
    v_exp_f32 v54, v54
    v_exp_f32 v55, v55
    v_mfma_f32_32x32x16_bf16 v[28:43], v[100:103], v[8:11], v[28:43]
    v_exp_f32 v56, v56
    v_exp_f32 v57, v57
    v_exp_f32 v58, v58
    v_exp_f32 v59, v59
    v_mfma_f32_32x32x16_bf16 v[76:91], v[112:115], v[64:67], v[76:91]
    ds_read_b128 v[96:99], v125 offset:31744
    ds_read_b64 v[104:105], v128 offset:30976
    s_mov_b64 exec, s[34:35]
    ds_read_b128 v[108:111], v131 offset:30720
    ds_read_b128 v[112:115], v131 offset:31360
    s_mov_b64 exec, -1
    v_cvt_pk_bf16_f32 v68, v44, v45
    v_cvt_pk_bf16_f32 v69, v46, v47
    v_cvt_pk_bf16_f32 v70, v48, v49
    v_cvt_pk_bf16_f32 v71, v50, v51
    v_cvt_pk_bf16_f32 v72, v52, v53
    v_cvt_pk_bf16_f32 v73, v54, v55
    v_cvt_pk_bf16_f32 v74, v56, v57
    v_cvt_pk_bf16_f32 v75, v58, v59
    s_waitcnt lgkmcnt(4)
    s_nop 0
    s_waitcnt lgkmcnt(2)
    v_exp_f32 v28, v28
    v_exp_f32 v29, v29
    v_exp_f32 v30, v30
    v_exp_f32 v31, v31
    v_mfma_f32_32x32x16_bf16 v[44:59], v[96:99], v[4:7], v[12:27]
    v_exp_f32 v32, v32
    v_exp_f32 v33, v33
    v_exp_f32 v34, v34
    v_exp_f32 v35, v35
    v_mfma_f32_32x32x16_bf16 v[76:91], v[116:119], v[68:71], v[76:91]
    v_exp_f32 v36, v36
    v_exp_f32 v37, v37
    v_exp_f32 v38, v38
    v_exp_f32 v39, v39
    v_mfma_f32_32x32x16_bf16 v[44:59], v[104:107], v[8:11], v[44:59]
    v_exp_f32 v40, v40
    v_exp_f32 v41, v41
    v_exp_f32 v42, v42
    v_exp_f32 v43, v43
    v_mfma_f32_32x32x16_bf16 v[76:91], v[120:123], v[72:75], v[76:91]
    ds_read_b128 v[92:95], v125 offset:35840
    ds_read_b64 v[100:101], v128 offset:35840
    s_mov_b64 exec, s[34:35]
    ds_read_b128 v[116:119], v131 offset:32000
    ds_read_b128 v[120:123], v131 offset:32640
    s_mov_b64 exec, -1
    v_cvt_pk_bf16_f32 v60, v28, v29
    v_cvt_pk_bf16_f32 v61, v30, v31
    v_cvt_pk_bf16_f32 v62, v32, v33
    v_cvt_pk_bf16_f32 v63, v34, v35
    v_cvt_pk_bf16_f32 v64, v36, v37
    v_cvt_pk_bf16_f32 v65, v38, v39
    v_cvt_pk_bf16_f32 v66, v40, v41
    v_cvt_pk_bf16_f32 v67, v42, v43
    s_waitcnt lgkmcnt(4)
    s_nop 0
    s_waitcnt lgkmcnt(2)
    v_exp_f32 v44, v44
    v_exp_f32 v45, v45
    v_exp_f32 v46, v46
    v_exp_f32 v47, v47
    v_mfma_f32_32x32x16_bf16 v[28:43], v[92:95], v[4:7], v[12:27]
    v_exp_f32 v48, v48
    v_exp_f32 v49, v49
    v_exp_f32 v50, v50
    v_exp_f32 v51, v51
    v_mfma_f32_32x32x16_bf16 v[76:91], v[108:111], v[60:63], v[76:91]
    v_exp_f32 v52, v52
    v_exp_f32 v53, v53
    v_exp_f32 v54, v54
    v_exp_f32 v55, v55
    v_mfma_f32_32x32x16_bf16 v[28:43], v[100:103], v[8:11], v[28:43]
    v_exp_f32 v56, v56
    v_exp_f32 v57, v57
    v_exp_f32 v58, v58
    v_exp_f32 v59, v59
    v_mfma_f32_32x32x16_bf16 v[76:91], v[112:115], v[64:67], v[76:91]
    ds_read_b128 v[96:99], v125 offset:36864
    ds_read_b64 v[104:105], v128 offset:36096
    s_mov_b64 exec, s[34:35]
    ds_read_b128 v[108:111], v131 offset:35840
    ds_read_b128 v[112:115], v131 offset:36480
    s_mov_b64 exec, -1
    v_cvt_pk_bf16_f32 v68, v44, v45
    v_cvt_pk_bf16_f32 v69, v46, v47
    v_cvt_pk_bf16_f32 v70, v48, v49
    v_cvt_pk_bf16_f32 v71, v50, v51
    v_cvt_pk_bf16_f32 v72, v52, v53
    v_cvt_pk_bf16_f32 v73, v54, v55
    v_cvt_pk_bf16_f32 v74, v56, v57
    v_cvt_pk_bf16_f32 v75, v58, v59
    s_waitcnt lgkmcnt(4)
    s_nop 0
    s_waitcnt lgkmcnt(2)
    v_exp_f32 v28, v28
    v_exp_f32 v29, v29
    v_exp_f32 v30, v30
    v_exp_f32 v31, v31
    v_mfma_f32_32x32x16_bf16 v[44:59], v[96:99], v[4:7], v[12:27]
    v_exp_f32 v32, v32
    v_exp_f32 v33, v33
    v_exp_f32 v34, v34
    v_exp_f32 v35, v35
    v_mfma_f32_32x32x16_bf16 v[76:91], v[116:119], v[68:71], v[76:91]
    v_exp_f32 v36, v36
    v_exp_f32 v37, v37
    v_exp_f32 v38, v38
    v_exp_f32 v39, v39
    v_mfma_f32_32x32x16_bf16 v[44:59], v[104:107], v[8:11], v[44:59]
    v_exp_f32 v40, v40
    v_exp_f32 v41, v41
    v_exp_f32 v42, v42
    v_exp_f32 v43, v43
    v_mfma_f32_32x32x16_bf16 v[76:91], v[120:123], v[72:75], v[76:91]
    s_waitcnt vmcnt(6)
    s_barrier
    ds_read_b128 v[92:95], v125 offset:40960
    ds_read_b64 v[100:101], v128 offset:40960
    s_mov_b64 exec, s[34:35]
    ds_read_b128 v[116:119], v131 offset:37120
    ds_read_b128 v[120:123], v131 offset:37760
    s_mov_b64 exec, -1
    v_cvt_pk_bf16_f32 v60, v28, v29
    v_cvt_pk_bf16_f32 v61, v30, v31
    v_cvt_pk_bf16_f32 v62, v32, v33
    v_cvt_pk_bf16_f32 v63, v34, v35
    v_cvt_pk_bf16_f32 v64, v36, v37
    v_cvt_pk_bf16_f32 v65, v38, v39
    v_cvt_pk_bf16_f32 v66, v40, v41
    v_cvt_pk_bf16_f32 v67, v42, v43
    s_waitcnt lgkmcnt(4)
    s_nop 0
    s_waitcnt lgkmcnt(2)
    v_exp_f32 v44, v44
    v_exp_f32 v45, v45
    v_exp_f32 v46, v46
    v_exp_f32 v47, v47
    v_mfma_f32_32x32x16_bf16 v[28:43], v[92:95], v[4:7], v[12:27]
    v_exp_f32 v48, v48
    v_exp_f32 v49, v49
    v_exp_f32 v50, v50
    v_exp_f32 v51, v51
    v_mfma_f32_32x32x16_bf16 v[76:91], v[108:111], v[60:63], v[76:91]
    v_exp_f32 v52, v52
    v_exp_f32 v53, v53
    v_exp_f32 v54, v54
    v_exp_f32 v55, v55
    v_mfma_f32_32x32x16_bf16 v[28:43], v[100:103], v[8:11], v[28:43]
    v_exp_f32 v56, v56
    v_exp_f32 v57, v57
    v_exp_f32 v58, v58
    v_exp_f32 v59, v59
    v_mfma_f32_32x32x16_bf16 v[76:91], v[112:115], v[64:67], v[76:91]
    ds_read_b128 v[96:99], v125 offset:41984
    ds_read_b64 v[104:105], v128 offset:41216
    s_mov_b64 exec, s[34:35]
    ds_read_b128 v[108:111], v131 offset:40960
    ds_read_b128 v[112:115], v131 offset:41600
    s_mov_b64 exec, -1
    v_cvt_pk_bf16_f32 v68, v44, v45
    v_cvt_pk_bf16_f32 v69, v46, v47
    v_cvt_pk_bf16_f32 v70, v48, v49
    v_cvt_pk_bf16_f32 v71, v50, v51
    v_cvt_pk_bf16_f32 v72, v52, v53
    v_cvt_pk_bf16_f32 v73, v54, v55
    v_cvt_pk_bf16_f32 v74, v56, v57
    v_cvt_pk_bf16_f32 v75, v58, v59
    s_waitcnt lgkmcnt(4)
    s_nop 0
    s_waitcnt lgkmcnt(2)
    v_exp_f32 v28, v28
    v_exp_f32 v29, v29
    v_exp_f32 v30, v30
    v_exp_f32 v31, v31
    v_mfma_f32_32x32x16_bf16 v[44:59], v[96:99], v[4:7], v[12:27]
    v_exp_f32 v32, v32
    v_exp_f32 v33, v33
    v_exp_f32 v34, v34
    v_exp_f32 v35, v35
    v_mfma_f32_32x32x16_bf16 v[76:91], v[116:119], v[68:71], v[76:91]
    v_exp_f32 v36, v36
    v_exp_f32 v37, v37
    v_exp_f32 v38, v38
    v_exp_f32 v39, v39
    v_mfma_f32_32x32x16_bf16 v[44:59], v[104:107], v[8:11], v[44:59]
    v_exp_f32 v40, v40
    v_exp_f32 v41, v41
    v_exp_f32 v42, v42
    v_exp_f32 v43, v43
    v_mfma_f32_32x32x16_bf16 v[76:91], v[120:123], v[72:75], v[76:91]
    ds_read_b128 v[92:95], v125 offset:46080
    ds_read_b64 v[100:101], v128 offset:46080
    s_mov_b64 exec, s[34:35]
    ds_read_b128 v[116:119], v131 offset:42240
    ds_read_b128 v[120:123], v131 offset:42880
    s_mov_b64 exec, -1
    v_cvt_pk_bf16_f32 v60, v28, v29
    v_cvt_pk_bf16_f32 v61, v30, v31
    v_cvt_pk_bf16_f32 v62, v32, v33
    v_cvt_pk_bf16_f32 v63, v34, v35
    v_cvt_pk_bf16_f32 v64, v36, v37
    v_cvt_pk_bf16_f32 v65, v38, v39
    v_cvt_pk_bf16_f32 v66, v40, v41
    v_cvt_pk_bf16_f32 v67, v42, v43
    s_waitcnt lgkmcnt(4)
    s_nop 0
    s_waitcnt lgkmcnt(2)
    v_exp_f32 v44, v44
    v_exp_f32 v45, v45
    v_exp_f32 v46, v46
    v_exp_f32 v47, v47
    v_mfma_f32_32x32x16_bf16 v[28:43], v[92:95], v[4:7], v[12:27]
    v_exp_f32 v48, v48
    v_exp_f32 v49, v49
    v_exp_f32 v50, v50
    v_exp_f32 v51, v51
    v_mfma_f32_32x32x16_bf16 v[76:91], v[108:111], v[60:63], v[76:91]
    v_exp_f32 v52, v52
    v_exp_f32 v53, v53
    v_exp_f32 v54, v54
    v_exp_f32 v55, v55
    v_mfma_f32_32x32x16_bf16 v[28:43], v[100:103], v[8:11], v[28:43]
    v_exp_f32 v56, v56
    v_exp_f32 v57, v57
    v_exp_f32 v58, v58
    v_exp_f32 v59, v59
    v_mfma_f32_32x32x16_bf16 v[76:91], v[112:115], v[64:67], v[76:91]
    ds_read_b128 v[96:99], v125 offset:47104
    ds_read_b64 v[104:105], v128 offset:46336
    s_mov_b64 exec, s[34:35]
    ds_read_b128 v[108:111], v131 offset:46080
    ds_read_b128 v[112:115], v131 offset:46720
    s_mov_b64 exec, -1
    v_cvt_pk_bf16_f32 v68, v44, v45
    v_cvt_pk_bf16_f32 v69, v46, v47
    v_cvt_pk_bf16_f32 v70, v48, v49
    v_cvt_pk_bf16_f32 v71, v50, v51
    v_cvt_pk_bf16_f32 v72, v52, v53
    v_cvt_pk_bf16_f32 v73, v54, v55
    v_cvt_pk_bf16_f32 v74, v56, v57
    v_cvt_pk_bf16_f32 v75, v58, v59
    s_waitcnt lgkmcnt(4)
    s_nop 0
    s_waitcnt lgkmcnt(2)
    v_exp_f32 v28, v28
    v_exp_f32 v29, v29
    v_exp_f32 v30, v30
    v_exp_f32 v31, v31
    v_mfma_f32_32x32x16_bf16 v[44:59], v[96:99], v[4:7], v[12:27]
    v_exp_f32 v32, v32
    v_exp_f32 v33, v33
    v_exp_f32 v34, v34
    v_exp_f32 v35, v35
    v_mfma_f32_32x32x16_bf16 v[76:91], v[116:119], v[68:71], v[76:91]
    v_exp_f32 v36, v36
    v_exp_f32 v37, v37
    v_exp_f32 v38, v38
    v_exp_f32 v39, v39
    v_mfma_f32_32x32x16_bf16 v[44:59], v[104:107], v[8:11], v[44:59]
    v_exp_f32 v40, v40
    v_exp_f32 v41, v41
    v_exp_f32 v42, v42
    v_exp_f32 v43, v43
    v_mfma_f32_32x32x16_bf16 v[76:91], v[120:123], v[72:75], v[76:91]
    s_waitcnt vmcnt(5)
    s_barrier
    ds_read_b128 v[92:95], v125 offset:51200
    ds_read_b64 v[100:101], v128 offset:51200
    s_mov_b64 exec, s[34:35]
    ds_read_b128 v[116:119], v131 offset:47360
    ds_read_b128 v[120:123], v131 offset:48000
    s_mov_b64 exec, -1
    v_cvt_pk_bf16_f32 v60, v28, v29
    v_cvt_pk_bf16_f32 v61, v30, v31
    v_cvt_pk_bf16_f32 v62, v32, v33
    v_cvt_pk_bf16_f32 v63, v34, v35
    v_cvt_pk_bf16_f32 v64, v36, v37
    v_cvt_pk_bf16_f32 v65, v38, v39
    v_cvt_pk_bf16_f32 v66, v40, v41
    v_cvt_pk_bf16_f32 v67, v42, v43
    s_waitcnt lgkmcnt(4)
    s_nop 0
    s_waitcnt lgkmcnt(2)
    v_exp_f32 v44, v44
    v_exp_f32 v45, v45
    v_exp_f32 v46, v46
    v_exp_f32 v47, v47
    v_mfma_f32_32x32x16_bf16 v[28:43], v[92:95], v[4:7], v[12:27]
    v_exp_f32 v48, v48
    v_exp_f32 v49, v49
    v_exp_f32 v50, v50
    v_exp_f32 v51, v51
    v_mfma_f32_32x32x16_bf16 v[76:91], v[108:111], v[60:63], v[76:91]
    v_exp_f32 v52, v52
    v_exp_f32 v53, v53
    v_exp_f32 v54, v54
    v_exp_f32 v55, v55
    v_mfma_f32_32x32x16_bf16 v[28:43], v[100:103], v[8:11], v[28:43]
    v_exp_f32 v56, v56
    v_exp_f32 v57, v57
    v_exp_f32 v58, v58
    v_exp_f32 v59, v59
    v_mfma_f32_32x32x16_bf16 v[76:91], v[112:115], v[64:67], v[76:91]
    ds_read_b128 v[96:99], v125 offset:52224
    ds_read_b64 v[104:105], v128 offset:51456
    s_mov_b64 exec, s[34:35]
    ds_read_b128 v[108:111], v131 offset:51200
    ds_read_b128 v[112:115], v131 offset:51840
    s_mov_b64 exec, -1
    v_cvt_pk_bf16_f32 v68, v44, v45
    v_cvt_pk_bf16_f32 v69, v46, v47
    v_cvt_pk_bf16_f32 v70, v48, v49
    v_cvt_pk_bf16_f32 v71, v50, v51
    v_cvt_pk_bf16_f32 v72, v52, v53
    v_cvt_pk_bf16_f32 v73, v54, v55
    v_cvt_pk_bf16_f32 v74, v56, v57
    v_cvt_pk_bf16_f32 v75, v58, v59
    s_waitcnt lgkmcnt(4)
    s_nop 0
    s_waitcnt lgkmcnt(2)
    v_exp_f32 v28, v28
    v_exp_f32 v29, v29
    v_exp_f32 v30, v30
    v_exp_f32 v31, v31
    v_mfma_f32_32x32x16_bf16 v[44:59], v[96:99], v[4:7], v[12:27]
    v_exp_f32 v32, v32
    v_exp_f32 v33, v33
    v_exp_f32 v34, v34
    v_exp_f32 v35, v35
    v_mfma_f32_32x32x16_bf16 v[76:91], v[116:119], v[68:71], v[76:91]
    v_exp_f32 v36, v36
    v_exp_f32 v37, v37
    v_exp_f32 v38, v38
    v_exp_f32 v39, v39
    v_mfma_f32_32x32x16_bf16 v[44:59], v[104:107], v[8:11], v[44:59]
    v_exp_f32 v40, v40
    v_exp_f32 v41, v41
    v_exp_f32 v42, v42
    v_exp_f32 v43, v43
    v_mfma_f32_32x32x16_bf16 v[76:91], v[120:123], v[72:75], v[76:91]
    ds_read_b128 v[92:95], v125 offset:56320
    ds_read_b64 v[100:101], v128 offset:56320
    s_mov_b64 exec, s[34:35]
    ds_read_b128 v[116:119], v131 offset:52480
    ds_read_b128 v[120:123], v131 offset:53120
    s_mov_b64 exec, -1
    v_cvt_pk_bf16_f32 v60, v28, v29
    v_cvt_pk_bf16_f32 v61, v30, v31
    v_cvt_pk_bf16_f32 v62, v32, v33
    v_cvt_pk_bf16_f32 v63, v34, v35
    v_cvt_pk_bf16_f32 v64, v36, v37
    v_cvt_pk_bf16_f32 v65, v38, v39
    v_cvt_pk_bf16_f32 v66, v40, v41
    v_cvt_pk_bf16_f32 v67, v42, v43
    s_waitcnt lgkmcnt(4)
    s_nop 0
    s_waitcnt lgkmcnt(2)
    v_exp_f32 v44, v44
    v_exp_f32 v45, v45
    v_exp_f32 v46, v46
    v_exp_f32 v47, v47
    v_mfma_f32_32x32x16_bf16 v[28:43], v[92:95], v[4:7], v[12:27]
    v_exp_f32 v48, v48
    v_exp_f32 v49, v49
    v_exp_f32 v50, v50
    v_exp_f32 v51, v51
    v_mfma_f32_32x32x16_bf16 v[76:91], v[108:111], v[60:63], v[76:91]
    v_exp_f32 v52, v52
    v_exp_f32 v53, v53
    v_exp_f32 v54, v54
    v_exp_f32 v55, v55
    v_mfma_f32_32x32x16_bf16 v[28:43], v[100:103], v[8:11], v[28:43]
    v_exp_f32 v56, v56
    v_exp_f32 v57, v57
    v_exp_f32 v58, v58
    v_exp_f32 v59, v59
    v_mfma_f32_32x32x16_bf16 v[76:91], v[112:115], v[64:67], v[76:91]
    ds_read_b128 v[96:99], v125 offset:57344
    ds_read_b64 v[104:105], v128 offset:56576
    s_mov_b64 exec, s[34:35]
    ds_read_b128 v[108:111], v131 offset:56320
    ds_read_b128 v[112:115], v131 offset:56960
    s_mov_b64 exec, -1
    v_cvt_pk_bf16_f32 v68, v44, v45
    v_cvt_pk_bf16_f32 v69, v46, v47
    v_cvt_pk_bf16_f32 v70, v48, v49
    v_cvt_pk_bf16_f32 v71, v50, v51
    v_cvt_pk_bf16_f32 v72, v52, v53
    v_cvt_pk_bf16_f32 v73, v54, v55
    v_cvt_pk_bf16_f32 v74, v56, v57
    v_cvt_pk_bf16_f32 v75, v58, v59
    s_waitcnt lgkmcnt(4)
    s_nop 0
    s_waitcnt lgkmcnt(2)
    v_exp_f32 v28, v28
    v_exp_f32 v29, v29
    v_exp_f32 v30, v30
    v_exp_f32 v31, v31
    v_mfma_f32_32x32x16_bf16 v[44:59], v[96:99], v[4:7], v[12:27]
    v_exp_f32 v32, v32
    v_exp_f32 v33, v33
    v_exp_f32 v34, v34
    v_exp_f32 v35, v35
    v_mfma_f32_32x32x16_bf16 v[76:91], v[116:119], v[68:71], v[76:91]
    v_exp_f32 v36, v36
    v_exp_f32 v37, v37
    v_exp_f32 v38, v38
    v_exp_f32 v39, v39
    v_mfma_f32_32x32x16_bf16 v[44:59], v[104:107], v[8:11], v[44:59]
    v_exp_f32 v40, v40
    v_exp_f32 v41, v41
    v_exp_f32 v42, v42
    v_exp_f32 v43, v43
    v_mfma_f32_32x32x16_bf16 v[76:91], v[120:123], v[72:75], v[76:91]
    s_waitcnt vmcnt(3)
    s_barrier
    ds_read_b128 v[92:95], v126
    ds_read_b64 v[100:101], v129
    s_mov_b64 exec, s[34:35]
    ds_read_b128 v[116:119], v131 offset:57600
    ds_read_b128 v[120:123], v131 offset:58240
    s_mov_b64 exec, -1
    v_cvt_pk_bf16_f32 v60, v28, v29
    v_cvt_pk_bf16_f32 v61, v30, v31
    v_cvt_pk_bf16_f32 v62, v32, v33
    v_cvt_pk_bf16_f32 v63, v34, v35
    v_cvt_pk_bf16_f32 v64, v36, v37
    v_cvt_pk_bf16_f32 v65, v38, v39
    v_cvt_pk_bf16_f32 v66, v40, v41
    v_cvt_pk_bf16_f32 v67, v42, v43
    s_waitcnt lgkmcnt(4)
    s_nop 0
    s_waitcnt lgkmcnt(2)
    v_exp_f32 v44, v44
    v_exp_f32 v45, v45
    v_exp_f32 v46, v46
    v_exp_f32 v47, v47
    v_mfma_f32_32x32x16_bf16 v[28:43], v[92:95], v[4:7], v[12:27]
    v_exp_f32 v48, v48
    v_exp_f32 v49, v49
    v_exp_f32 v50, v50
    v_exp_f32 v51, v51
    v_mfma_f32_32x32x16_bf16 v[76:91], v[108:111], v[60:63], v[76:91]
    v_exp_f32 v52, v52
    v_exp_f32 v53, v53
    v_exp_f32 v54, v54
    v_exp_f32 v55, v55
    v_mfma_f32_32x32x16_bf16 v[28:43], v[100:103], v[8:11], v[28:43]
    v_exp_f32 v56, v56
    v_exp_f32 v57, v57
    v_exp_f32 v58, v58
    v_exp_f32 v59, v59
    v_mfma_f32_32x32x16_bf16 v[76:91], v[112:115], v[64:67], v[76:91]
    ds_read_b128 v[96:99], v126 offset:1024
    ds_read_b64 v[104:105], v129 offset:256
    s_mov_b64 exec, s[34:35]
    ds_read_b128 v[108:111], v132
    ds_read_b128 v[112:115], v132 offset:640
    s_mov_b64 exec, -1
    v_cvt_pk_bf16_f32 v68, v44, v45
    v_cvt_pk_bf16_f32 v69, v46, v47
    v_cvt_pk_bf16_f32 v70, v48, v49
    v_cvt_pk_bf16_f32 v71, v50, v51
    v_cvt_pk_bf16_f32 v72, v52, v53
    v_cvt_pk_bf16_f32 v73, v54, v55
    v_cvt_pk_bf16_f32 v74, v56, v57
    v_cvt_pk_bf16_f32 v75, v58, v59
    s_waitcnt lgkmcnt(4)
    s_nop 0
    s_waitcnt lgkmcnt(2)
    v_exp_f32 v28, v28
    v_exp_f32 v29, v29
    v_exp_f32 v30, v30
    v_exp_f32 v31, v31
    v_mfma_f32_32x32x16_bf16 v[44:59], v[96:99], v[4:7], v[12:27]
    v_exp_f32 v32, v32
    v_exp_f32 v33, v33
    v_exp_f32 v34, v34
    v_exp_f32 v35, v35
    v_mfma_f32_32x32x16_bf16 v[76:91], v[116:119], v[68:71], v[76:91]
    v_exp_f32 v36, v36
    v_exp_f32 v37, v37
    v_exp_f32 v38, v38
    v_exp_f32 v39, v39
    v_mfma_f32_32x32x16_bf16 v[44:59], v[104:107], v[8:11], v[44:59]
    v_exp_f32 v40, v40
    v_exp_f32 v41, v41
    v_exp_f32 v42, v42
    v_exp_f32 v43, v43
    v_mfma_f32_32x32x16_bf16 v[76:91], v[120:123], v[72:75], v[76:91]
    ds_read_b128 v[92:95], v126 offset:5120
    ds_read_b64 v[100:101], v129 offset:5120
    s_mov_b64 exec, s[34:35]
    ds_read_b128 v[116:119], v132 offset:1280
    ds_read_b128 v[120:123], v132 offset:1920
    s_mov_b64 exec, -1
    v_cvt_pk_bf16_f32 v60, v28, v29
    v_cvt_pk_bf16_f32 v61, v30, v31
    v_cvt_pk_bf16_f32 v62, v32, v33
    v_cvt_pk_bf16_f32 v63, v34, v35
    v_cvt_pk_bf16_f32 v64, v36, v37
    v_cvt_pk_bf16_f32 v65, v38, v39
    v_cvt_pk_bf16_f32 v66, v40, v41
    v_cvt_pk_bf16_f32 v67, v42, v43
    s_waitcnt lgkmcnt(4)
    s_nop 0
    s_waitcnt lgkmcnt(2)
    v_exp_f32 v44, v44
    v_exp_f32 v45, v45
    v_exp_f32 v46, v46
    v_exp_f32 v47, v47
    v_mfma_f32_32x32x16_bf16 v[28:43], v[92:95], v[4:7], v[12:27]
    v_exp_f32 v48, v48
    v_exp_f32 v49, v49
    v_exp_f32 v50, v50
    v_exp_f32 v51, v51
    v_mfma_f32_32x32x16_bf16 v[76:91], v[108:111], v[60:63], v[76:91]
    v_exp_f32 v52, v52
    v_exp_f32 v53, v53
    v_exp_f32 v54, v54
    v_exp_f32 v55, v55
    v_mfma_f32_32x32x16_bf16 v[28:43], v[100:103], v[8:11], v[28:43]
    v_exp_f32 v56, v56
    v_exp_f32 v57, v57
    v_exp_f32 v58, v58
    v_exp_f32 v59, v59
    v_mfma_f32_32x32x16_bf16 v[76:91], v[112:115], v[64:67], v[76:91]
    ds_read_b128 v[96:99], v126 offset:6144
    ds_read_b64 v[104:105], v129 offset:5376
    s_mov_b64 exec, s[34:35]
    ds_read_b128 v[108:111], v132 offset:5120
    ds_read_b128 v[112:115], v132 offset:5760
    s_mov_b64 exec, -1
    v_cvt_pk_bf16_f32 v68, v44, v45
    v_cvt_pk_bf16_f32 v69, v46, v47
    v_cvt_pk_bf16_f32 v70, v48, v49
    v_cvt_pk_bf16_f32 v71, v50, v51
    v_cvt_pk_bf16_f32 v72, v52, v53
    v_cvt_pk_bf16_f32 v73, v54, v55
    v_cvt_pk_bf16_f32 v74, v56, v57
    v_cvt_pk_bf16_f32 v75, v58, v59
    s_waitcnt lgkmcnt(4)
    s_nop 0
    s_waitcnt lgkmcnt(2)
    v_exp_f32 v28, v28
    v_exp_f32 v29, v29
    v_exp_f32 v30, v30
    v_exp_f32 v31, v31
    v_mfma_f32_32x32x16_bf16 v[44:59], v[96:99], v[4:7], v[12:27]
    v_exp_f32 v32, v32
    v_exp_f32 v33, v33
    v_exp_f32 v34, v34
    v_exp_f32 v35, v35
    v_mfma_f32_32x32x16_bf16 v[76:91], v[116:119], v[68:71], v[76:91]
    v_exp_f32 v36, v36
    v_exp_f32 v37, v37
    v_exp_f32 v38, v38
    v_exp_f32 v39, v39
    v_mfma_f32_32x32x16_bf16 v[44:59], v[104:107], v[8:11], v[44:59]
    v_exp_f32 v40, v40
    v_exp_f32 v41, v41
    v_exp_f32 v42, v42
    v_exp_f32 v43, v43
    v_mfma_f32_32x32x16_bf16 v[76:91], v[120:123], v[72:75], v[76:91]
    s_waitcnt vmcnt(2)
    s_barrier
    ds_read_b128 v[92:95], v126 offset:10240
    ds_read_b64 v[100:101], v129 offset:10240
    s_mov_b64 exec, s[34:35]
    ds_read_b128 v[116:119], v132 offset:6400
    ds_read_b128 v[120:123], v132 offset:7040
    s_mov_b64 exec, -1
    v_cvt_pk_bf16_f32 v60, v28, v29
    v_cvt_pk_bf16_f32 v61, v30, v31
    v_cvt_pk_bf16_f32 v62, v32, v33
    v_cvt_pk_bf16_f32 v63, v34, v35
    v_cvt_pk_bf16_f32 v64, v36, v37
    v_cvt_pk_bf16_f32 v65, v38, v39
    v_cvt_pk_bf16_f32 v66, v40, v41
    v_cvt_pk_bf16_f32 v67, v42, v43
    s_waitcnt lgkmcnt(4)
    s_nop 0
    s_waitcnt lgkmcnt(2)
    v_exp_f32 v44, v44
    v_exp_f32 v45, v45
    v_exp_f32 v46, v46
    v_exp_f32 v47, v47
    v_mfma_f32_32x32x16_bf16 v[28:43], v[92:95], v[4:7], v[12:27]
    v_exp_f32 v48, v48
    v_exp_f32 v49, v49
    v_exp_f32 v50, v50
    v_exp_f32 v51, v51
    v_mfma_f32_32x32x16_bf16 v[76:91], v[108:111], v[60:63], v[76:91]
    v_exp_f32 v52, v52
    v_exp_f32 v53, v53
    v_exp_f32 v54, v54
    v_exp_f32 v55, v55
    v_mfma_f32_32x32x16_bf16 v[28:43], v[100:103], v[8:11], v[28:43]
    v_exp_f32 v56, v56
    v_exp_f32 v57, v57
    v_exp_f32 v58, v58
    v_exp_f32 v59, v59
    v_mfma_f32_32x32x16_bf16 v[76:91], v[112:115], v[64:67], v[76:91]
    ds_read_b128 v[96:99], v126 offset:11264
    ds_read_b64 v[104:105], v129 offset:10496
    s_mov_b64 exec, s[34:35]
    ds_read_b128 v[108:111], v132 offset:10240
    ds_read_b128 v[112:115], v132 offset:10880
    s_mov_b64 exec, -1
    v_cvt_pk_bf16_f32 v68, v44, v45
    v_cvt_pk_bf16_f32 v69, v46, v47
    v_cvt_pk_bf16_f32 v70, v48, v49
    v_cvt_pk_bf16_f32 v71, v50, v51
    v_cvt_pk_bf16_f32 v72, v52, v53
    v_cvt_pk_bf16_f32 v73, v54, v55
    v_cvt_pk_bf16_f32 v74, v56, v57
    v_cvt_pk_bf16_f32 v75, v58, v59
    s_waitcnt lgkmcnt(4)
    s_nop 0
    s_waitcnt lgkmcnt(2)
    v_exp_f32 v28, v28
    v_exp_f32 v29, v29
    v_exp_f32 v30, v30
    v_exp_f32 v31, v31
    v_mfma_f32_32x32x16_bf16 v[44:59], v[96:99], v[4:7], v[12:27]
    v_exp_f32 v32, v32
    v_exp_f32 v33, v33
    v_exp_f32 v34, v34
    v_exp_f32 v35, v35
    v_mfma_f32_32x32x16_bf16 v[76:91], v[116:119], v[68:71], v[76:91]
    v_exp_f32 v36, v36
    v_exp_f32 v37, v37
    v_exp_f32 v38, v38
    v_exp_f32 v39, v39
    v_mfma_f32_32x32x16_bf16 v[44:59], v[104:107], v[8:11], v[44:59]
    v_exp_f32 v40, v40
    v_exp_f32 v41, v41
    v_exp_f32 v42, v42
    v_exp_f32 v43, v43
    v_mfma_f32_32x32x16_bf16 v[76:91], v[120:123], v[72:75], v[76:91]
    ds_read_b128 v[92:95], v126 offset:15360
    ds_read_b64 v[100:101], v129 offset:15360
    s_mov_b64 exec, s[34:35]
    ds_read_b128 v[116:119], v132 offset:11520
    ds_read_b128 v[120:123], v132 offset:12160
    s_mov_b64 exec, -1
    v_cvt_pk_bf16_f32 v60, v28, v29
    v_cvt_pk_bf16_f32 v61, v30, v31
    v_cvt_pk_bf16_f32 v62, v32, v33
    v_cvt_pk_bf16_f32 v63, v34, v35
    v_cvt_pk_bf16_f32 v64, v36, v37
    v_cvt_pk_bf16_f32 v65, v38, v39
    v_cvt_pk_bf16_f32 v66, v40, v41
    v_cvt_pk_bf16_f32 v67, v42, v43
    s_waitcnt lgkmcnt(4)
    s_nop 0
    s_waitcnt lgkmcnt(2)
    v_exp_f32 v44, v44
    v_exp_f32 v45, v45
    v_exp_f32 v46, v46
    v_exp_f32 v47, v47
    v_mfma_f32_32x32x16_bf16 v[28:43], v[92:95], v[4:7], v[12:27]
    v_exp_f32 v48, v48
    v_exp_f32 v49, v49
    v_exp_f32 v50, v50
    v_exp_f32 v51, v51
    v_mfma_f32_32x32x16_bf16 v[76:91], v[108:111], v[60:63], v[76:91]
    v_exp_f32 v52, v52
    v_exp_f32 v53, v53
    v_exp_f32 v54, v54
    v_exp_f32 v55, v55
    v_mfma_f32_32x32x16_bf16 v[28:43], v[100:103], v[8:11], v[28:43]
    v_exp_f32 v56, v56
    v_exp_f32 v57, v57
    v_exp_f32 v58, v58
    v_exp_f32 v59, v59
    v_mfma_f32_32x32x16_bf16 v[76:91], v[112:115], v[64:67], v[76:91]
    ds_read_b128 v[96:99], v126 offset:16384
    ds_read_b64 v[104:105], v129 offset:15616
    s_mov_b64 exec, s[34:35]
    ds_read_b128 v[108:111], v132 offset:15360
    ds_read_b128 v[112:115], v132 offset:16000
    s_mov_b64 exec, -1
    v_cvt_pk_bf16_f32 v68, v44, v45
    v_cvt_pk_bf16_f32 v69, v46, v47
    v_cvt_pk_bf16_f32 v70, v48, v49
    v_cvt_pk_bf16_f32 v71, v50, v51
    v_cvt_pk_bf16_f32 v72, v52, v53
    v_cvt_pk_bf16_f32 v73, v54, v55
    v_cvt_pk_bf16_f32 v74, v56, v57
    v_cvt_pk_bf16_f32 v75, v58, v59
    s_waitcnt lgkmcnt(4)
    s_nop 0
    s_waitcnt lgkmcnt(2)
    v_exp_f32 v28, v28
    v_exp_f32 v29, v29
    v_exp_f32 v30, v30
    v_exp_f32 v31, v31
    v_mfma_f32_32x32x16_bf16 v[44:59], v[96:99], v[4:7], v[12:27]
    v_exp_f32 v32, v32
    v_exp_f32 v33, v33
    v_exp_f32 v34, v34
    v_exp_f32 v35, v35
    v_mfma_f32_32x32x16_bf16 v[76:91], v[116:119], v[68:71], v[76:91]
    v_exp_f32 v36, v36
    v_exp_f32 v37, v37
    v_exp_f32 v38, v38
    v_exp_f32 v39, v39
    v_mfma_f32_32x32x16_bf16 v[44:59], v[104:107], v[8:11], v[44:59]
    v_exp_f32 v40, v40
    v_exp_f32 v41, v41
    v_exp_f32 v42, v42
    v_exp_f32 v43, v43
    v_mfma_f32_32x32x16_bf16 v[76:91], v[120:123], v[72:75], v[76:91]
    s_waitcnt vmcnt(1)
    s_barrier
    ds_read_b128 v[92:95], v126 offset:20480
    ds_read_b64 v[100:101], v129 offset:20480
    s_mov_b64 exec, s[34:35]
    ds_read_b128 v[116:119], v132 offset:16640
    ds_read_b128 v[120:123], v132 offset:17280
    s_mov_b64 exec, -1
    v_cvt_pk_bf16_f32 v60, v28, v29
    v_cvt_pk_bf16_f32 v61, v30, v31
    v_cvt_pk_bf16_f32 v62, v32, v33
    v_cvt_pk_bf16_f32 v63, v34, v35
    v_cvt_pk_bf16_f32 v64, v36, v37
    v_cvt_pk_bf16_f32 v65, v38, v39
    v_cvt_pk_bf16_f32 v66, v40, v41
    v_cvt_pk_bf16_f32 v67, v42, v43
    s_waitcnt lgkmcnt(4)
    s_nop 0
    s_waitcnt lgkmcnt(2)
    v_exp_f32 v44, v44
    v_exp_f32 v45, v45
    v_exp_f32 v46, v46
    v_exp_f32 v47, v47
    v_mfma_f32_32x32x16_bf16 v[28:43], v[92:95], v[4:7], v[12:27]
    v_exp_f32 v48, v48
    v_exp_f32 v49, v49
    v_exp_f32 v50, v50
    v_exp_f32 v51, v51
    v_mfma_f32_32x32x16_bf16 v[76:91], v[108:111], v[60:63], v[76:91]
    v_exp_f32 v52, v52
    v_exp_f32 v53, v53
    v_exp_f32 v54, v54
    v_exp_f32 v55, v55
    v_mfma_f32_32x32x16_bf16 v[28:43], v[100:103], v[8:11], v[28:43]
    v_exp_f32 v56, v56
    v_exp_f32 v57, v57
    v_exp_f32 v58, v58
    v_exp_f32 v59, v59
    v_mfma_f32_32x32x16_bf16 v[76:91], v[112:115], v[64:67], v[76:91]
    ds_read_b128 v[96:99], v126 offset:21504
    ds_read_b64 v[104:105], v129 offset:20736
    s_mov_b64 exec, s[34:35]
    ds_read_b128 v[108:111], v132 offset:20480
    ds_read_b128 v[112:115], v132 offset:21120
    s_mov_b64 exec, -1
    v_cvt_pk_bf16_f32 v68, v44, v45
    v_cvt_pk_bf16_f32 v69, v46, v47
    v_cvt_pk_bf16_f32 v70, v48, v49
    v_cvt_pk_bf16_f32 v71, v50, v51
    v_cvt_pk_bf16_f32 v72, v52, v53
    v_cvt_pk_bf16_f32 v73, v54, v55
    v_cvt_pk_bf16_f32 v74, v56, v57
    v_cvt_pk_bf16_f32 v75, v58, v59
    s_waitcnt lgkmcnt(4)
    s_nop 0
    s_waitcnt lgkmcnt(2)
    v_exp_f32 v28, v28
    v_exp_f32 v29, v29
    v_exp_f32 v30, v30
    v_exp_f32 v31, v31
    v_mfma_f32_32x32x16_bf16 v[44:59], v[96:99], v[4:7], v[12:27]
    v_exp_f32 v32, v32
    v_exp_f32 v33, v33
    v_exp_f32 v34, v34
    v_exp_f32 v35, v35
    v_mfma_f32_32x32x16_bf16 v[76:91], v[116:119], v[68:71], v[76:91]
    v_exp_f32 v36, v36
    v_exp_f32 v37, v37
    v_exp_f32 v38, v38
    v_exp_f32 v39, v39
    v_mfma_f32_32x32x16_bf16 v[44:59], v[104:107], v[8:11], v[44:59]
    v_exp_f32 v40, v40
    v_exp_f32 v41, v41
    v_exp_f32 v42, v42
    v_exp_f32 v43, v43
    v_mfma_f32_32x32x16_bf16 v[76:91], v[120:123], v[72:75], v[76:91]
    ds_read_b128 v[92:95], v126 offset:25600
    ds_read_b64 v[100:101], v129 offset:25600
    s_mov_b64 exec, s[34:35]
    ds_read_b128 v[116:119], v132 offset:21760
    ds_read_b128 v[120:123], v132 offset:22400
    s_mov_b64 exec, -1
    v_cvt_pk_bf16_f32 v60, v28, v29
    v_cvt_pk_bf16_f32 v61, v30, v31
    v_cvt_pk_bf16_f32 v62, v32, v33
    v_cvt_pk_bf16_f32 v63, v34, v35
    v_cvt_pk_bf16_f32 v64, v36, v37
    v_cvt_pk_bf16_f32 v65, v38, v39
    v_cvt_pk_bf16_f32 v66, v40, v41
    v_cvt_pk_bf16_f32 v67, v42, v43
    s_waitcnt lgkmcnt(4)
    s_nop 0
    s_waitcnt lgkmcnt(2)
    v_exp_f32 v44, v44
    v_exp_f32 v45, v45
    v_exp_f32 v46, v46
    v_exp_f32 v47, v47
    v_mfma_f32_32x32x16_bf16 v[28:43], v[92:95], v[4:7], v[12:27]
    v_exp_f32 v48, v48
    v_exp_f32 v49, v49
    v_exp_f32 v50, v50
    v_exp_f32 v51, v51
    v_mfma_f32_32x32x16_bf16 v[76:91], v[108:111], v[60:63], v[76:91]
    v_exp_f32 v52, v52
    v_exp_f32 v53, v53
    v_exp_f32 v54, v54
    v_exp_f32 v55, v55
    v_mfma_f32_32x32x16_bf16 v[28:43], v[100:103], v[8:11], v[28:43]
    v_exp_f32 v56, v56
    v_exp_f32 v57, v57
    v_exp_f32 v58, v58
    v_exp_f32 v59, v59
    v_mfma_f32_32x32x16_bf16 v[76:91], v[112:115], v[64:67], v[76:91]
    ds_read_b128 v[96:99], v126 offset:26624
    ds_read_b64 v[104:105], v129 offset:25856
    s_mov_b64 exec, s[34:35]
    ds_read_b128 v[108:111], v132 offset:25600
    ds_read_b128 v[112:115], v132 offset:26240
    s_mov_b64 exec, -1
    v_cvt_pk_bf16_f32 v68, v44, v45
    v_cvt_pk_bf16_f32 v69, v46, v47
    v_cvt_pk_bf16_f32 v70, v48, v49
    v_cvt_pk_bf16_f32 v71, v50, v51
    v_cvt_pk_bf16_f32 v72, v52, v53
    v_cvt_pk_bf16_f32 v73, v54, v55
    v_cvt_pk_bf16_f32 v74, v56, v57
    v_cvt_pk_bf16_f32 v75, v58, v59
    s_waitcnt lgkmcnt(4)
    s_nop 0
    s_waitcnt lgkmcnt(2)
    v_exp_f32 v28, v28
    v_exp_f32 v29, v29
    v_exp_f32 v30, v30
    v_exp_f32 v31, v31
    v_mfma_f32_32x32x16_bf16 v[44:59], v[96:99], v[4:7], v[12:27]
    v_exp_f32 v32, v32
    v_exp_f32 v33, v33
    v_exp_f32 v34, v34
    v_exp_f32 v35, v35
    v_mfma_f32_32x32x16_bf16 v[76:91], v[116:119], v[68:71], v[76:91]
    v_exp_f32 v36, v36
    v_exp_f32 v37, v37
    v_exp_f32 v38, v38
    v_exp_f32 v39, v39
    v_mfma_f32_32x32x16_bf16 v[44:59], v[104:107], v[8:11], v[44:59]
    v_exp_f32 v40, v40
    v_exp_f32 v41, v41
    v_exp_f32 v42, v42
    v_exp_f32 v43, v43
    v_mfma_f32_32x32x16_bf16 v[76:91], v[120:123], v[72:75], v[76:91]
    s_waitcnt vmcnt(0)
    s_barrier
    ds_read_b128 v[92:95], v126 offset:30720
    ds_read_b64 v[100:101], v129 offset:30720
    s_mov_b64 exec, s[34:35]
    ds_read_b128 v[116:119], v132 offset:26880
    ds_read_b128 v[120:123], v132 offset:27520
    s_mov_b64 exec, -1
    v_cvt_pk_bf16_f32 v60, v28, v29
    v_cvt_pk_bf16_f32 v61, v30, v31
    v_cvt_pk_bf16_f32 v62, v32, v33
    v_cvt_pk_bf16_f32 v63, v34, v35
    v_cvt_pk_bf16_f32 v64, v36, v37
    v_cvt_pk_bf16_f32 v65, v38, v39
    v_cvt_pk_bf16_f32 v66, v40, v41
    v_cvt_pk_bf16_f32 v67, v42, v43
    s_waitcnt lgkmcnt(4)
    s_nop 0
    s_waitcnt lgkmcnt(2)
    v_exp_f32 v44, v44
    v_exp_f32 v45, v45
    v_exp_f32 v46, v46
    v_exp_f32 v47, v47
    v_mfma_f32_32x32x16_bf16 v[28:43], v[92:95], v[4:7], v[12:27]
    v_exp_f32 v48, v48
    v_exp_f32 v49, v49
    v_exp_f32 v50, v50
    v_exp_f32 v51, v51
    v_mfma_f32_32x32x16_bf16 v[76:91], v[108:111], v[60:63], v[76:91]
    v_exp_f32 v52, v52
    v_exp_f32 v53, v53
    v_exp_f32 v54, v54
    v_exp_f32 v55, v55
    v_mfma_f32_32x32x16_bf16 v[28:43], v[100:103], v[8:11], v[28:43]
    v_exp_f32 v56, v56
    v_exp_f32 v57, v57
    v_exp_f32 v58, v58
    v_exp_f32 v59, v59
    v_mfma_f32_32x32x16_bf16 v[76:91], v[112:115], v[64:67], v[76:91]
    ds_read_b128 v[96:99], v126 offset:31744
    ds_read_b64 v[104:105], v129 offset:30976
    s_mov_b64 exec, s[34:35]
    ds_read_b128 v[108:111], v132 offset:30720
    ds_read_b128 v[112:115], v132 offset:31360
    s_mov_b64 exec, -1
    v_cvt_pk_bf16_f32 v68, v44, v45
    v_cvt_pk_bf16_f32 v69, v46, v47
    v_cvt_pk_bf16_f32 v70, v48, v49
    v_cvt_pk_bf16_f32 v71, v50, v51
    v_cvt_pk_bf16_f32 v72, v52, v53
    v_cvt_pk_bf16_f32 v73, v54, v55
    v_cvt_pk_bf16_f32 v74, v56, v57
    v_cvt_pk_bf16_f32 v75, v58, v59
    s_waitcnt lgkmcnt(4)
    s_nop 0
    s_waitcnt lgkmcnt(2)
    v_exp_f32 v28, v28
    v_exp_f32 v29, v29
    v_exp_f32 v30, v30
    v_exp_f32 v31, v31
    v_mfma_f32_32x32x16_bf16 v[44:59], v[96:99], v[4:7], v[12:27]
    v_exp_f32 v32, v32
    v_exp_f32 v33, v33
    v_exp_f32 v34, v34
    v_exp_f32 v35, v35
    v_mfma_f32_32x32x16_bf16 v[76:91], v[116:119], v[68:71], v[76:91]
    v_exp_f32 v36, v36
    v_exp_f32 v37, v37
    v_exp_f32 v38, v38
    v_exp_f32 v39, v39
    v_mfma_f32_32x32x16_bf16 v[44:59], v[104:107], v[8:11], v[44:59]
    v_exp_f32 v40, v40
    v_exp_f32 v41, v41
    v_exp_f32 v42, v42
    v_exp_f32 v43, v43
    v_mfma_f32_32x32x16_bf16 v[76:91], v[120:123], v[72:75], v[76:91]
    ds_read_b128 v[92:95], v126 offset:35840
    ds_read_b64 v[100:101], v129 offset:35840
    s_mov_b64 exec, s[34:35]
    ds_read_b128 v[116:119], v132 offset:32000
    ds_read_b128 v[120:123], v132 offset:32640
    s_mov_b64 exec, -1
    v_cvt_pk_bf16_f32 v60, v28, v29
    v_cvt_pk_bf16_f32 v61, v30, v31
    v_cvt_pk_bf16_f32 v62, v32, v33
    v_cvt_pk_bf16_f32 v63, v34, v35
    v_cvt_pk_bf16_f32 v64, v36, v37
    v_cvt_pk_bf16_f32 v65, v38, v39
    v_cvt_pk_bf16_f32 v66, v40, v41
    v_cvt_pk_bf16_f32 v67, v42, v43
    s_waitcnt lgkmcnt(4)
    s_nop 0
    s_waitcnt lgkmcnt(2)
    v_exp_f32 v44, v44
    v_exp_f32 v45, v45
    v_exp_f32 v46, v46
    v_exp_f32 v47, v47
    v_mfma_f32_32x32x16_bf16 v[28:43], v[92:95], v[4:7], v[12:27]
    v_exp_f32 v48, v48
    v_exp_f32 v49, v49
    v_exp_f32 v50, v50
    v_exp_f32 v51, v51
    v_mfma_f32_32x32x16_bf16 v[76:91], v[108:111], v[60:63], v[76:91]
    v_exp_f32 v52, v52
    v_exp_f32 v53, v53
    v_exp_f32 v54, v54
    v_exp_f32 v55, v55
    v_mfma_f32_32x32x16_bf16 v[28:43], v[100:103], v[8:11], v[28:43]
    v_exp_f32 v56, v56
    v_exp_f32 v57, v57
    v_exp_f32 v58, v58
    v_exp_f32 v59, v59
    v_mfma_f32_32x32x16_bf16 v[76:91], v[112:115], v[64:67], v[76:91]
    ds_read_b128 v[96:99], v126 offset:36864
    ds_read_b64 v[104:105], v129 offset:36096
    s_mov_b64 exec, s[34:35]
    ds_read_b128 v[108:111], v132 offset:35840
    ds_read_b128 v[112:115], v132 offset:36480
    s_mov_b64 exec, -1
    v_cvt_pk_bf16_f32 v68, v44, v45
    v_cvt_pk_bf16_f32 v69, v46, v47
    v_cvt_pk_bf16_f32 v70, v48, v49
    v_cvt_pk_bf16_f32 v71, v50, v51
    v_cvt_pk_bf16_f32 v72, v52, v53
    v_cvt_pk_bf16_f32 v73, v54, v55
    v_cvt_pk_bf16_f32 v74, v56, v57
    v_cvt_pk_bf16_f32 v75, v58, v59
    s_waitcnt lgkmcnt(4)
    s_nop 0
    s_waitcnt lgkmcnt(2)
    v_exp_f32 v28, v28
    v_exp_f32 v29, v29
    v_exp_f32 v30, v30
    v_exp_f32 v31, v31
    v_mfma_f32_32x32x16_bf16 v[44:59], v[96:99], v[4:7], v[12:27]
    v_exp_f32 v32, v32
    v_exp_f32 v33, v33
    v_exp_f32 v34, v34
    v_exp_f32 v35, v35
    v_mfma_f32_32x32x16_bf16 v[76:91], v[116:119], v[68:71], v[76:91]
    v_exp_f32 v36, v36
    v_exp_f32 v37, v37
    v_exp_f32 v38, v38
    v_exp_f32 v39, v39
    v_mfma_f32_32x32x16_bf16 v[44:59], v[104:107], v[8:11], v[44:59]
    v_exp_f32 v40, v40
    v_exp_f32 v41, v41
    v_exp_f32 v42, v42
    v_exp_f32 v43, v43
    v_mfma_f32_32x32x16_bf16 v[76:91], v[120:123], v[72:75], v[76:91]
    s_mov_b64 exec, s[34:35]
    ds_read_b128 v[116:119], v132 offset:37120
    ds_read_b128 v[120:123], v132 offset:37760
    s_mov_b64 exec, -1
    v_cvt_pk_bf16_f32 v60, v28, v29
    v_cvt_pk_bf16_f32 v61, v30, v31
    v_cvt_pk_bf16_f32 v62, v32, v33
    v_cvt_pk_bf16_f32 v63, v34, v35
    v_cvt_pk_bf16_f32 v64, v36, v37
    v_cvt_pk_bf16_f32 v65, v38, v39
    v_cvt_pk_bf16_f32 v66, v40, v41
    v_cvt_pk_bf16_f32 v67, v42, v43
    s_waitcnt lgkmcnt(2)
    s_nop 0
    v_exp_f32 v44, v44
    v_exp_f32 v45, v45
    v_exp_f32 v46, v46
    v_exp_f32 v47, v47
    v_exp_f32 v48, v48
    v_exp_f32 v49, v49
    v_exp_f32 v50, v50
    v_exp_f32 v51, v51
    v_mfma_f32_32x32x16_bf16 v[76:91], v[108:111], v[60:63], v[76:91]
    v_exp_f32 v52, v52
    v_exp_f32 v53, v53
    v_exp_f32 v54, v54
    v_exp_f32 v55, v55
    v_exp_f32 v56, v56
    v_exp_f32 v57, v57
    v_exp_f32 v58, v58
    v_exp_f32 v59, v59
    v_mfma_f32_32x32x16_bf16 v[76:91], v[112:115], v[64:67], v[76:91]
    v_cvt_pk_bf16_f32 v68, v44, v45
    v_cvt_pk_bf16_f32 v69, v46, v47
    v_cvt_pk_bf16_f32 v70, v48, v49
    v_cvt_pk_bf16_f32 v71, v50, v51
    v_cvt_pk_bf16_f32 v72, v52, v53
    v_cvt_pk_bf16_f32 v73, v54, v55
    v_cvt_pk_bf16_f32 v74, v56, v57
    v_cvt_pk_bf16_f32 v75, v58, v59
    s_waitcnt lgkmcnt(0)
    s_nop 0
    v_mfma_f32_32x32x16_bf16 v[76:91], v[116:119], v[68:71], v[76:91]
    v_mfma_f32_32x32x16_bf16 v[76:91], v[120:123], v[72:75], v[76:91]
    s_nop 15
    s_nop 3
    v_mov_b32 v134, 0x5f800000
    v_cmp_nlt_f32 vcc, v84, v134
    s_mov_b32 s36, 0
    s_mov_b32 s37, -1
    s_and_b64 s[36:37], s[36:37], vcc
    s_cmp_eq_u64 s[36:37], 0
    s_cbranch_scc1 L_mha_attn_kernel_fin
    v_mov_b32 v76, 0
    v_mov_b32 v77, 0
    v_mov_b32 v78, 0
    v_mov_b32 v79, 0
    v_mov_b32 v80, 0
    v_mov_b32 v81, 0
    v_mov_b32 v82, 0
    v_mov_b32 v83, 0
    v_mov_b32 v84, 0
    v_mov_b32 v85, 0
    v_mov_b32 v86, 0
    v_mov_b32 v87, 0
    v_mov_b32 v88, 0
    v_mov_b32 v89, 0
    v_mov_b32 v90, 0
    v_mov_b32 v91, 0
    v_mov_b32 v136, 0xff800000
    v_mov_b32 v138, v124
    v_mov_b32 v139, v127
    s_mov_b32 s38, 0
L_mha_attn_kernel_mx:
    ds_read_b128 v[92:95], v138
    ds_read_b64 v[100:101], v139
    s_waitcnt lgkmcnt(0)
    v_mfma_f32_32x32x16_bf16 v[28:43], v[92:95], v[4:7], v[76:91]
    v_mfma_f32_32x32x16_bf16 v[28:43], v[100:103], v[8:11], v[28:43]
    s_nop 15
    s_nop 3
    v_max3_f32 v136, v136, v28, v29
    v_max3_f32 v136, v136, v30, v31
    v_max3_f32 v136, v136, v32, v33
    v_max3_f32 v136, v136, v34, v35
    v_max3_f32 v136, v136, v36, v37
    v_max3_f32 v136, v136, v38, v39
    v_max3_f32 v136, v136, v40, v41
    v_max3_f32 v136, v136, v42, v43
    ds_read_b128 v[92:95], v138 offset:1024
    ds_read_b64 v[100:101], v139 offset:256
    s_waitcnt lgkmcnt(0)
    v_mfma_f32_32x32x16_bf16 v[28:43], v[92:95], v[4:7], v[76:91]
    v_mfma_f32_32x32x16_bf16 v[28:43], v[100:103], v[8:11], v[28:43]
    s_nop 15
    s_nop 3
    v_max3_f32 v136, v136, v28, v29
    v_max3_f32 v136, v136, v30, v31
    v_max3_f32 v136, v136, v32, v33
    v_max3_f32 v136, v136, v34, v35
    v_max3_f32 v136, v136, v36, v37
    v_max3_f32 v136, v136, v38, v39
    v_max3_f32 v136, v136, v40, v41
    v_max3_f32 v136, v136, v42, v43
    v_add_u32 v138, 5120, v138
    v_add_u32 v139, 5120, v139
    s_add_u32 s38, s38, 1
    s_cmp_lt_u32 s38, 32
    s_cbranch_scc1 L_mha_attn_kernel_mx
    v_mov_b32 v137, v136
    s_nop 1
    v_permlane32_swap_b32 v136, v137
    s_nop 1
    v_max_f32 v136, v136, v137
    v_sub_f32 v136, 0, v136
    v_mov_b32 v12, v136
    v_mov_b32 v13, v136
    v_mov_b32 v14, v136
    v_mov_b32 v15, v136
    v_mov_b32 v16, v136
    v_mov_b32 v17, v136
    v_mov_b32 v18, v136
    v_mov_b32 v19, v136
    v_mov_b32 v20, v136
    v_mov_b32 v21, v136
    v_mov_b32 v22, v136
    v_mov_b32 v23, v136
    v_mov_b32 v24, v136
    v_mov_b32 v25, v136
    v_mov_b32 v26, v136
    v_mov_b32 v27, v136
    v_mov_b32 v138, v124
    v_mov_b32 v139, v127
    v_mov_b32 v140, v130
    s_mov_b32 s38, 0
L_mha_attn_kernel_rl:
    ds_read_b128 v[92:95], v138
    ds_read_b64 v[100:101], v139
    s_mov_b64 exec, s[34:35]
    ds_read_b128 v[108:111], v140
    ds_read_b128 v[112:115], v140 offset:640
    s_mov_b64 exec, -1
    s_waitcnt lgkmcnt(0)
    v_mfma_f32_32x32x16_bf16 v[28:43], v[92:95], v[4:7], v[12:27]
    v_mfma_f32_32x32x16_bf16 v[28:43], v[100:103], v[8:11], v[28:43]
    s_nop 15
    s_nop 3
    v_exp_f32 v28, v28
    v_exp_f32 v29, v29
    v_exp_f32 v30, v30
    v_exp_f32 v31, v31
    v_exp_f32 v32, v32
    v_exp_f32 v33, v33
    v_exp_f32 v34, v34
    v_exp_f32 v35, v35
    v_exp_f32 v36, v36
    v_exp_f32 v37, v37
    v_exp_f32 v38, v38
    v_exp_f32 v39, v39
    v_exp_f32 v40, v40
    v_exp_f32 v41, v41
    v_exp_f32 v42, v42
    v_exp_f32 v43, v43
    s_nop 0
    v_cvt_pk_bf16_f32 v60, v28, v29
    v_cvt_pk_bf16_f32 v61, v30, v31
    v_cvt_pk_bf16_f32 v62, v32, v33
    v_cvt_pk_bf16_f32 v63, v34, v35
    v_cvt_pk_bf16_f32 v64, v36, v37
    v_cvt_pk_bf16_f32 v65, v38, v39
    v_cvt_pk_bf16_f32 v66, v40, v41
    v_cvt_pk_bf16_f32 v67, v42, v43
    s_nop 1
    v_mfma_f32_32x32x16_bf16 v[76:91], v[108:111], v[60:63], v[76:91]
    v_mfma_f32_32x32x16_bf16 v[76:91], v[112:115], v[64:67], v[76:91]
    ds_read_b128 v[92:95], v138 offset:1024
    ds_read_b64 v[100:101], v139 offset:256
    s_mov_b64 exec, s[34:35]
    ds_read_b128 v[108:111], v140 offset:1280
    ds_read_b128 v[112:115], v140 offset:1920
    s_mov_b64 exec, -1
    s_waitcnt lgkmcnt(0)
    v_mfma_f32_32x32x16_bf16 v[28:43], v[92:95], v[4:7], v[12:27]
    v_mfma_f32_32x32x16_bf16 v[28:43], v[100:103], v[8:11], v[28:43]
    s_nop 15
    s_nop 3
    v_exp_f32 v28, v28
    v_exp_f32 v29, v29
    v_exp_f32 v30, v30
    v_exp_f32 v31, v31
    v_exp_f32 v32, v32
    v_exp_f32 v33, v33
    v_exp_f32 v34, v34
    v_exp_f32 v35, v35
    v_exp_f32 v36, v36
    v_exp_f32 v37, v37
    v_exp_f32 v38, v38
    v_exp_f32 v39, v39
    v_exp_f32 v40, v40
    v_exp_f32 v41, v41
    v_exp_f32 v42, v42
    v_exp_f32 v43, v43
    s_nop 0
    v_cvt_pk_bf16_f32 v60, v28, v29
    v_cvt_pk_bf16_f32 v61, v30, v31
    v_cvt_pk_bf16_f32 v62, v32, v33
    v_cvt_pk_bf16_f32 v63, v34, v35
    v_cvt_pk_bf16_f32 v64, v36, v37
    v_cvt_pk_bf16_f32 v65, v38, v39
    v_cvt_pk_bf16_f32 v66, v40, v41
    v_cvt_pk_bf16_f32 v67, v42, v43
    s_nop 1
    v_mfma_f32_32x32x16_bf16 v[76:91], v[108:111], v[60:63], v[76:91]
    v_mfma_f32_32x32x16_bf16 v[76:91], v[112:115], v[64:67], v[76:91]
    v_add_u32 v138, 5120, v138
    v_add_u32 v139, 5120, v139
    v_add_u32 v140, 5120, v140
    s_add_u32 s38, s38, 1
    s_cmp_lt_u32 s38, 32
    s_cbranch_scc1 L_mha_attn_kernel_rl
    s_nop 15
    s_nop 3
L_mha_attn_kernel_fin:
    v_mov_b32 v134, v84
    v_mov_b32 v135, v84
    s_nop 1
    v_permlane32_swap_b32 v134, v135
    s_nop 1
    v_rcp_f32 v135, v135
    s_nop 0
    v_mul_f32 v76, v76, v135
    v_mul_f32 v77, v77, v135
    v_mul_f32 v78, v78, v135
    v_mul_f32 v79, v79, v135
    v_mul_f32 v80, v80, v135
    v_mul_f32 v81, v81, v135
    v_mul_f32 v82, v82, v135
    v_mul_f32 v83, v83, v135
    v_mul_f32 v84, v84, v135
    v_mul_f32 v85, v85, v135
    v_mul_f32 v86, v86, v135
    v_mul_f32 v87, v87, v135
    v_cvt_pk_bf16_f32 v76, v76, v77
    v_cvt_pk_bf16_f32 v77, v78, v79
    v_cvt_pk_bf16_f32 v78, v80, v81
    v_cvt_pk_bf16_f32 v79, v82, v83
    v_cvt_pk_bf16_f32 v80, v84, v85
    v_cvt_pk_bf16_f32 v81, v86, v87
    s_lshl_b32 s30, s25, 8
    s_lshl_b32 s31, s20, 5
    s_add_u32 s30, s30, s31
    v_and_b32 v134, 31, v1
    v_add_u32 v134, s30, v134
    v_mul_u32_u24 v134, 1280, v134
    v_lshrrev_b32 v135, 5, v1
    v_lshl_add_u32 v134, v135, 3, v134
    s_mul_i32 s31, s24, 40
    s_add_u32 s31, s31, 10485760
    buffer_store_dwordx2 v[76:77], v134, s[44:47], s31 offen
    buffer_store_dwordx2 v[78:79], v134, s[44:47], s31 offen offset:16
    s_mov_b64 exec, 0xffffffff
    buffer_store_dwordx2 v[80:81], v134, s[44:47], s31 offen offset:32
    s_mov_b64 exec, -1
L_mha_attn_kernel_end:
    s_endpgm
.globl mha_oproj_kernel
.p2align 8
.type mha_oproj_kernel,@function
mha_oproj_kernel:
    s_cmp_ge_u32 s2, 80
    s_cbranch_scc1 L_mha_oproj_kernel_end
    s_load_dwordx4 s[4:7], s[0:1], 0
    s_load_dwordx4 s[8:11], s[0:1], 16
    s_load_dwordx2 s[26:27], s[0:1], 40
    v_and_b32 v1, 63, v0
    v_lshrrev_b32 v20, 6, v0
    s_nop 0
    v_readfirstlane_b32 s20, v20
    s_and_b32 s21, s2, 7
    s_lshr_b32 s22, s2, 3
    s_and_b32 s23, s22, 1
    s_lshl_b32 s21, s21, 1
    s_add_u32 s24, s21, s23
    s_lshr_b32 s25, s22, 1
    s_waitcnt lgkmcnt(0)
    s_add_u32 s12, s26, 10485760
    s_addc_u32 s13, s27, 0
    s_mov_b32 s14, 2621440
    s_mov_b32 s15, 0x00020000
    s_mov_b32 s16, s8
    s_mov_b32 s17, s9
    s_mov_b32 s18, 819200
    s_mov_b32 s19, 0x00020000
    s_mov_b32 s44, s26
    s_mov_b32 s45, s27
    s_mov_b32 s46, 268435456
    s_mov_b32 s47, 0x00020000
    v_lshrrev_b32 v20, 3, v1
    v_mul_u32_u24 v20, 1280, v20
    v_and_b32 v21, 7, v1
    v_lshrrev_b32 v22, 4, v1
    v_xor_b32 v21, v21, v22
    v_lshlrev_b32 v23, 4, v21
    v_add_u32 v2, v20, v23
    v_xor_b32 v21, 4, v21
    v_lshlrev_b32 v23, 4, v21
    v_add_u32 v3, v20, v23
    v_lshrrev_b32 v20, 4, v1
    v_mul_u32_u24 v21, 1280, v20
    v_and_b32 v22, 15, v1
    v_lshlrev_b32 v20, 2, v20
    v_xor_b32 v22, v22, v20
    v_lshlrev_b32 v22, 4, v22
    v_add_u32 v4, v21, v22
    s_lshl_b32 s30, s24, 7
    s_lshl_b32 s32, s20, 5
    s_add_u32 s30, s30, s32
    s_mul_i32 s30, s30, 1280
    s_lshl_b32 s31, s20, 4
    s_mul_i32 s31, s31, 1280
    s_lshl_b32 s32, s25, 8
    s_add_u32 s31, s31, s32
    s_lshl_b32 s33, s20, 12
    s_lshl_b32 s34, s20, 12
    s_add_u32 m0, s33, 0
    s_add_u32 s35, s30, 0
    buffer_load_dwordx4 v2, s[12:15], s35 offen lds
    s_add_u32 m0, s33, 1024
    s_add_u32 s35, s30, 10240
    buffer_load_dwordx4 v3, s[12:15], s35 offen lds
    s_add_u32 m0, s33, 2048
    s_add_u32 s35, s30, 20480
    buffer_load_dwordx4 v2, s[12:15], s35 offen lds
    s_add_u32 m0, s33, 3072
    s_add_u32 s35, s30, 30720
    buffer_load_dwordx4 v3, s[12:15], s35 offen lds
    s_add_u32 m0, s34, 16384
    s_add_u32 s35, s31, 0
    buffer_load_dwordx4 v4, s[16:19], s35 offen lds
    s_add_u32 m0, s34, 17408
    s_add_u32 s35, s31, 5120
    buffer_load_dwordx4 v4, s[16:19], s35 offen lds
    s_add_u32 m0, s34, 18432
    s_add_u32 s35, s31, 10240
    buffer_load_dwordx4 v4, s[16:19], s35 offen lds
    s_add_u32 m0, s34, 19456
    s_add_u32 s35, s31, 15360
    buffer_load_dwordx4 v4, s[16:19], s35 offen lds
    s_add_u32 m0, s33, 32768
    s_add_u32 s35, s30, 128
    buffer_load_dwordx4 v2, s[12:15], s35 offen lds
    s_add_u32 m0, s33, 33792
    s_add_u32 s35, s30, 10368
    buffer_load_dwordx4 v3, s[12:15], s35 offen lds
    s_add_u32 m0, s33, 34816
    s_add_u32 s35, s30, 20608
    buffer_load_dwordx4 v2, s[12:15], s35 offen lds
    s_add_u32 m0, s33, 35840
    s_add_u32 s35, s30, 30848
    buffer_load_dwordx4 v3, s[12:15], s35 offen lds
    s_add_u32 m0, s34, 49152
    s_add_u32 s35, s31, 81920
    buffer_load_dwordx4 v4, s[16:19], s35 offen lds
    s_add_u32 m0, s34, 50176
    s_add_u32 s35, s31, 87040
    buffer_load_dwordx4 v4, s[16:19], s35 offen lds
    s_add_u32 m0, s34, 51200
    s_add_u32 s35, s31, 92160
    buffer_load_dwordx4 v4, s[16:19], s35 offen lds
    s_add_u32 m0, s34, 52224
    s_add_u32 s35, s31, 97280
    buffer_load_dwordx4 v4, s[16:19], s35 offen lds
    s_add_u32 m0, s33, 65536
    s_add_u32 s35, s30, 256
    buffer_load_dwordx4 v2, s[12:15], s35 offen lds
    s_add_u32 m0, s33, 66560
    s_add_u32 s35, s30, 10496
    buffer_load_dwordx4 v3, s[12:15], s35 offen lds
    s_add_u32 m0, s33, 67584
    s_add_u32 s35, s30, 20736
    buffer_load_dwordx4 v2, s[12:15], s35 offen lds
    s_add_u32 m0, s33, 68608
    s_add_u32 s35, s30, 30976
    buffer_load_dwordx4 v3, s[12:15], s35 offen lds
    s_add_u32 m0, s34, 81920
    s_add_u32 s35, s31, 163840
    buffer_load_dwordx4 v4, s[16:19], s35 offen lds
    s_add_u32 m0, s34, 82944
    s_add_u32 s35, s31, 168960
    buffer_load_dwordx4 v4, s[16:19], s35 offen lds
    s_add_u32 m0, s34, 83968
    s_add_u32 s35, s31, 174080
    buffer_load_dwordx4 v4, s[16:19], s35 offen lds
    s_add_u32 m0, s34, 84992
    s_add_u32 s35, s31, 179200
    buffer_load_dwordx4 v4, s[16:19], s35 offen lds
    v_and_b32 v20, 31, v1
    v_lshrrev_b32 v21, 5, v1
    v_lshrrev_b32 v22, 1, v20
    v_and_b32 v22, 7, v22
    v_xor_b32 v22, v22, v21
    v_lshlrev_b32 v22, 4, v22
    v_lshlrev_b32 v23, 7, v20
    v_add_u32 v23, v23, v22
    s_lshr_b32 s36, s20, 1
    s_lshl_b32 s36, s36, 13
    v_add_u32 v23, s36, v23
    v_xor_b32 v8, 0, v23
    v_xor_b32 v9, 32, v23
    v_xor_b32 v10, 64, v23
    v_xor_b32 v11, 96, v23
    v_xor_b32 v12, 0, v23
    v_add_u32 v12, 0x10000, v12
    v_xor_b32 v13, 32, v23
    v_add_u32 v13, 0x10000, v13
    v_xor_b32 v14, 64, v23
    v_add_u32 v14, 0x10000, v14
    v_xor_b32 v15, 96, v23
    v_add_u32 v15, 0x10000, v15
    v_lshrrev_b32 v20, 4, v1
    v_and_b32 v21, 15, v1
    v_lshrrev_b32 v22, 2, v21
    v_and_b32 v23, 3, v21
    v_lshrrev_b32 v24, 1, v20
    v_lshlrev_b32 v24, 3, v24
    v_add_u32 v24, v24, v22
    v_lshlrev_b32 v24, 8, v24
    v_and_b32 v25, 1, v20
    v_lshlrev_b32 v25, 1, v25
    v_lshrrev_b32 v26, 1, v23
    v_add_u32 v25, v25, v26
    v_lshlrev_b32 v26, 2, v22
    v_xor_b32 v25, v25, v26
    v_lshlrev_b32 v25, 4, v25
    v_add_u32 v24, v24, v25
    v_and_b32 v25, 1, v23
    v_lshlrev_b32 v25, 3, v25
    v_add_u32 v24, v24, v25
    s_and_b32 s36, s20, 1
    s_lshl_b32 s36, s36, 7
    v_xor_b32 v16, s36, v24
    v_xor_b32 v17, s36, v24
    v_xor_b32 v17, 64, v17
    v_xor_b32 v18, s36, v24
    v_add_u32 v18, 0x10000, v18
    v_xor_b32 v19, s36, v24
    v_xor_b32 v19, 64, v19
    v_add_u32 v19, 0x10000, v19
    v_mov_b32 v64, 0
    v_mov_b32 v65, 0
    v_mov_b32 v66, 0
    v_mov_b32 v67, 0
    v_mov_b32 v68, 0
    v_mov_b32 v69, 0
    v_mov_b32 v70, 0
    v_mov_b32 v71, 0
    v_mov_b32 v72, 0
    v_mov_b32 v73, 0
    v_mov_b32 v74, 0
    v_mov_b32 v75, 0
    v_mov_b32 v76, 0
    v_mov_b32 v77, 0
    v_mov_b32 v78, 0
    v_mov_b32 v79, 0
    v_mov_b32 v80, 0
    v_mov_b32 v81, 0
    v_mov_b32 v82, 0
    v_mov_b32 v83, 0
    v_mov_b32 v84, 0
    v_mov_b32 v85, 0
    v_mov_b32 v86, 0
    v_mov_b32 v87, 0
    v_mov_b32 v88, 0
    v_mov_b32 v89, 0
    v_mov_b32 v90, 0
    v_mov_b32 v91, 0
    v_mov_b32 v92, 0
    v_mov_b32 v93, 0
    v_mov_b32 v94, 0
    v_mov_b32 v95, 0
    v_mov_b32 v96, 0
    v_mov_b32 v97, 0
    v_mov_b32 v98, 0
    v_mov_b32 v99, 0
    v_mov_b32 v100, 0
    v_mov_b32 v101, 0
    v_mov_b32 v102, 0
    v_mov_b32 v103, 0
    v_mov_b32 v104, 0
    v_mov_b32 v105, 0
    v_mov_b32 v106, 0
    v_mov_b32 v107, 0
    v_mov_b32 v108, 0
    v_mov_b32 v109, 0
    v_mov_b32 v110, 0
    v_mov_b32 v111, 0
    v_mov_b32 v112, 0
    v_mov_b32 v113, 0
    v_mov_b32 v114, 0
    v_mov_b32 v115, 0
    v_mov_b32 v116, 0
    v_mov_b32 v117, 0
    v_mov_b32 v118, 0
    v_mov_b32 v119, 0
    v_mov_b32 v120, 0
    v_mov_b32 v121, 0
    v_mov_b32 v122, 0
    v_mov_b32 v123, 0
    v_mov_b32 v124, 0
    v_mov_b32 v125, 0
    v_mov_b32 v126, 0
    v_mov_b32 v127, 0
    s_waitcnt vmcnt(16)
    s_barrier
    ds_read_b128 v[32:35], v8
    ds_read_b128 v[36:39], v8 offset:4096
    ds_read_b64_tr_b16 v[48:49], v16 offset:16384
    ds_read_b64_tr_b16 v[50:51], v16 offset:17408
    ds_read_b64_tr_b16 v[52:53], v17 offset:16384
    ds_read_b64_tr_b16 v[54:55], v17 offset:17408
    ds_read_b128 v[40:43], v9
    ds_read_b128 v[44:47], v9 offset:4096
    ds_read_b64_tr_b16 v[56:57], v16 offset:20480
    ds_read_b64_tr_b16 v[58:59], v16 offset:21504
    ds_read_b64_tr_b16 v[60:61], v17 offset:20480
    ds_read_b64_tr_b16 v[62:63], v17 offset:21504
    s_waitcnt lgkmcnt(6)
    v_mfma_f32_32x32x16_bf16 v[64:79], v[48:51], v[32:35], v[64:79]
    s_add_u32 m0, s33, 98304
    s_add_u32 s35, s30, 384
    buffer_load_dwordx4 v2, s[12:15], s35 offen lds
    v_mfma_f32_32x32x16_bf16 v[80:95], v[48:51], v[36:39], v[80:95]
    v_mfma_f32_32x32x16_bf16 v[96:111], v[52:55], v[32:35], v[96:111]
    s_add_u32 m0, s33, 99328
    s_add_u32 s35, s30, 10624
    buffer_load_dwordx4 v3, s[12:15], s35 offen lds
    v_mfma_f32_32x32x16_bf16 v[112:127], v[52:55], v[36:39], v[112:127]
    ds_read_b128 v[32:35], v10
    ds_read_b128 v[36:39], v10 offset:4096
    ds_read_b64_tr_b16 v[48:49], v16 offset:24576
    ds_read_b64_tr_b16 v[50:51], v16 offset:25600
    ds_read_b64_tr_b16 v[52:53], v17 offset:24576
    ds_read_b64_tr_b16 v[54:55], v17 offset:25600
    s_waitcnt lgkmcnt(6)
    v_mfma_f32_32x32x16_bf16 v[64:79], v[56:59], v[40:43], v[64:79]
    s_add_u32 m0, s33, 100352
    s_add_u32 s35, s30, 20864
    buffer_load_dwordx4 v2, s[12:15], s35 offen lds
    v_mfma_f32_32x32x16_bf16 v[80:95], v[56:59], v[44:47], v[80:95]
    v_mfma_f32_32x32x16_bf16 v[96:111], v[60:63], v[40:43], v[96:111]
    s_add_u32 m0, s33, 101376
    s_add_u32 s35, s30, 31104
    buffer_load_dwordx4 v3, s[12:15], s35 offen lds
    v_mfma_f32_32x32x16_bf16 v[112:127], v[60:63], v[44:47], v[112:127]
    ds_read_b128 v[40:43], v11
    ds_read_b128 v[44:47], v11 offset:4096
    ds_read_b64_tr_b16 v[56:57], v16 offset:28672
    ds_read_b64_tr_b16 v[58:59], v16 offset:29696
    ds_read_b64_tr_b16 v[60:61], v17 offset:28672
    ds_read_b64_tr_b16 v[62:63], v17 offset:29696
    s_waitcnt lgkmcnt(6)
    v_mfma_f32_32x32x16_bf16 v[64:79], v[48:51], v[32:35], v[64:79]
    s_add_u32 m0, s34, 114688
    s_add_u32 s35, s31, 245760
    buffer_load_dwordx4 v4, s[16:19], s35 offen lds
    v_mfma_f32_32x32x16_bf16 v[80:95], v[48:51], v[36:39], v[80:95]
    v_mfma_f32_32x32x16_bf16 v[96:111], v[52:55], v[32:35], v[96:111]
    s_add_u32 m0, s34, 115712
    s_add_u32 s35, s31, 250880
    buffer_load_dwordx4 v4, s[16:19], s35 offen lds
    v_mfma_f32_32x32x16_bf16 v[112:127], v[52:55], v[36:39], v[112:127]
    s_waitcnt lgkmcnt(0)
    v_mfma_f32_32x32x16_bf16 v[64:79], v[56:59], v[40:43], v[64:79]
    s_add_u32 m0, s34, 116736
    s_add_u32 s35, s31, 256000
    buffer_load_dwordx4 v4, s[16:19], s35 offen lds
    v_mfma_f32_32x32x16_bf16 v[80:95], v[56:59], v[44:47], v[80:95]
    v_mfma_f32_32x32x16_bf16 v[96:111], v[60:63], v[40:43], v[96:111]
    s_add_u32 m0, s34, 117760
    s_add_u32 s35, s31, 261120
    buffer_load_dwordx4 v4, s[16:19], s35 offen lds
    v_mfma_f32_32x32x16_bf16 v[112:127], v[60:63], v[44:47], v[112:127]
    s_waitcnt vmcnt(16)
    s_barrier
    ds_read_b128 v[32:35], v8 offset:32768
    ds_read_b128 v[36:39], v8 offset:36864
    ds_read_b64_tr_b16 v[48:49], v16 offset:49152
    ds_read_b64_tr_b16 v[50:51], v16 offset:50176
    ds_read_b64_tr_b16 v[52:53], v17 offset:49152
    ds_read_b64_tr_b16 v[54:55], v17 offset:50176
    ds_read_b128 v[40:43], v9 offset:32768
    ds_read_b128 v[44:47], v9 offset:36864
    ds_read_b64_tr_b16 v[56:57], v16 offset:53248
    ds_read_b64_tr_b16 v[58:59], v16 offset:54272
    ds_read_b64_tr_b16 v[60:61], v17 offset:53248
    ds_read_b64_tr_b16 v[62:63], v17 offset:54272
    s_waitcnt lgkmcnt(6)
    v_mfma_f32_32x32x16_bf16 v[64:79], v[48:51], v[32:35], v[64:79]
    s_add_u32 m0, s33, 0
    s_add_u32 s35, s30, 512
    buffer_load_dwordx4 v2, s[12:15], s35 offen lds
    v_mfma_f32_32x32x16_bf16 v[80:95], v[48:51], v[36:39], v[80:95]
    v_mfma_f32_32x32x16_bf16 v[96:111], v[52:55], v[32:35], v[96:111]
    s_add_u32 m0, s33, 1024
    s_add_u32 s35, s30, 10752
    buffer_load_dwordx4 v3, s[12:15], s35 offen lds
    v_mfma_f32_32x32x16_bf16 v[112:127], v[52:55], v[36:39], v[112:127]
    ds_read_b128 v[32:35], v10 offset:32768
    ds_read_b128 v[36:39], v10 offset:36864
    ds_read_b64_tr_b16 v[48:49], v16 offset:57344
    ds_read_b64_tr_b16 v[50:51], v16 offset:58368
    ds_read_b64_tr_b16 v[52:53], v17 offset:57344
    ds_read_b64_tr_b16 v[54:55], v17 offset:58368
    s_waitcnt lgkmcnt(6)
    v_mfma_f32_32x32x16_bf16 v[64:79], v[56:59], v[40:43], v[64:79]
    s_add_u32 m0, s33, 2048
    s_add_u32 s35, s30, 20992
    buffer_load_dwordx4 v2, s[12:15], s35 offen lds
    v_mfma_f32_32x32x16_bf16 v[80:95], v[56:59], v[44:47], v[80:95]
    v_mfma_f32_32x32x16_bf16 v[96:111], v[60:63], v[40:43], v[96:111]
    s_add_u32 m0, s33, 3072
    s_add_u32 s35, s30, 31232
    buffer_load_dwordx4 v3, s[12:15], s35 offen lds
    v_mfma_f32_32x32x16_bf16 v[112:127], v[60:63], v[44:47], v[112:127]
    ds_read_b128 v[40:43], v11 offset:32768
    ds_read_b128 v[44:47], v11 offset:36864
    ds_read_b64_tr_b16 v[56:57], v16 offset:61440
    ds_read_b64_tr_b16 v[58:59], v16 offset:62464
    ds_read_b64_tr_b16 v[60:61], v17 offset:61440
    ds_read_b64_tr_b16 v[62:63], v17 offset:62464
    s_waitcnt lgkmcnt(6)
    v_mfma_f32_32x32x16_bf16 v[64:79], v[48:51], v[32:35], v[64:79]
    s_add_u32 m0, s34, 16384
    s_add_u32 s35, s31, 327680
    buffer_load_dwordx4 v4, s[16:19], s35 offen lds
    v_mfma_f32_32x32x16_bf16 v[80:95], v[48:51], v[36:39], v[80:95]
    v_mfma_f32_32x32x16_bf16 v[96:111], v[52:55], v[32:35], v[96:111]
    s_add_u32 m0, s34, 17408
    s_add_u32 s35, s31, 332800
    buffer_load_dwordx4 v4, s[16:19], s35 offen lds
    v_mfma_f32_32x32x16_bf16 v[112:127], v[52:55], v[36:39], v[112:127]
    s_waitcnt lgkmcnt(0)
    v_mfma_f32_32x32x16_bf16 v[64:79], v[56:59], v[40:43], v[64:79]
    s_add_u32 m0, s34, 18432
    s_add_u32 s35, s31, 337920
    buffer_load_dwordx4 v4, s[16:19], s35 offen lds
    v_mfma_f32_32x32x16_bf16 v[80:95], v[56:59], v[44:47], v[80:95]
    v_mfma_f32_32x32x16_bf16 v[96:111], v[60:63], v[40:43], v[96:111]
    s_add_u32 m0, s34, 19456
    s_add_u32 s35, s31, 343040
    buffer_load_dwordx4 v4, s[16:19], s35 offen lds
    v_mfma_f32_32x32x16_bf16 v[112:127], v[60:63], v[44:47], v[112:127]
    s_waitcnt vmcnt(16)
    s_barrier
    ds_read_b128 v[32:35], v12
    ds_read_b128 v[36:39], v12 offset:4096
    ds_read_b64_tr_b16 v[48:49], v18 offset:16384
    ds_read_b64_tr_b16 v[50:51], v18 offset:17408
    ds_read_b64_tr_b16 v[52:53], v19 offset:16384
    ds_read_b64_tr_b16 v[54:55], v19 offset:17408
    ds_read_b128 v[40:43], v13
    ds_read_b128 v[44:47], v13 offset:4096
    ds_read_b64_tr_b16 v[56:57], v18 offset:20480
    ds_read_b64_tr_b16 v[58:59], v18 offset:21504
    ds_read_b64_tr_b16 v[60:61], v19 offset:20480
    ds_read_b64_tr_b16 v[62:63], v19 offset:21504
    s_waitcnt lgkmcnt(6)
    v_mfma_f32_32x32x16_bf16 v[64:79], v[48:51], v[32:35], v[64:79]
    s_add_u32 m0, s33, 32768
    s_add_u32 s35, s30, 640
    buffer_load_dwordx4 v2, s[12:15], s35 offen lds
    v_mfma_f32_32x32x16_bf16 v[80:95], v[48:51], v[36:39], v[80:95]
    v_mfma_f32_32x32x16_bf16 v[96:111], v[52:55], v[32:35], v[96:111]
    s_add_u32 m0, s33, 33792
    s_add_u32 s35, s30, 10880
    buffer_load_dwordx4 v3, s[12:15], s35 offen lds
    v_mfma_f32_32x32x16_bf16 v[112:127], v[52:55], v[36:39], v[112:127]
    ds_read_b128 v[32:35], v14
    ds_read_b128 v[36:39], v14 offset:4096
    ds_read_b64_tr_b16 v[48:49], v18 offset:24576
    ds_read_b64_tr_b16 v[50:51], v18 offset:25600
    ds_read_b64_tr_b16 v[52:53], v19 offset:24576
    ds_read_b64_tr_b16 v[54:55], v19 offset:25600
    s_waitcnt lgkmcnt(6)
    v_mfma_f32_32x32x16_bf16 v[64:79], v[56:59], v[40:43], v[64:79]
    s_add_u32 m0, s33, 34816
    s_add_u32 s35, s30, 21120
    buffer_load_dwordx4 v2, s[12:15], s35 offen lds
    v_mfma_f32_32x32x16_bf16 v[80:95], v[56:59], v[44:47], v[80:95]
    v_mfma_f32_32x32x16_bf16 v[96:111], v[60:63], v[40:43], v[96:111]
    s_add_u32 m0, s33, 35840
    s_add_u32 s35, s30, 31360
    buffer_load_dwordx4 v3, s[12:15], s35 offen lds
    v_mfma_f32_32x32x16_bf16 v[112:127], v[60:63], v[44:47], v[112:127]
    ds_read_b128 v[40:43], v15
    ds_read_b128 v[44:47], v15 offset:4096
    ds_read_b64_tr_b16 v[56:57], v18 offset:28672
    ds_read_b64_tr_b16 v[58:59], v18 offset:29696
    ds_read_b64_tr_b16 v[60:61], v19 offset:28672
    ds_read_b64_tr_b16 v[62:63], v19 offset:29696
    s_waitcnt lgkmcnt(6)
    v_mfma_f32_32x32x16_bf16 v[64:79], v[48:51], v[32:35], v[64:79]
    s_add_u32 m0, s34, 49152
    s_add_u32 s35, s31, 409600
    buffer_load_dwordx4 v4, s[16:19], s35 offen lds
    v_mfma_f32_32x32x16_bf16 v[80:95], v[48:51], v[36:39], v[80:95]
    v_mfma_f32_32x32x16_bf16 v[96:111], v[52:55], v[32:35], v[96:111]
    s_add_u32 m0, s34, 50176
    s_add_u32 s35, s31, 414720
    buffer_load_dwordx4 v4, s[16:19], s35 offen lds
    v_mfma_f32_32x32x16_bf16 v[112:127], v[52:55], v[36:39], v[112:127]
    s_waitcnt lgkmcnt(0)
    v_mfma_f32_32x32x16_bf16 v[64:79], v[56:59], v[40:43], v[64:79]
    s_add_u32 m0, s34, 51200
    s_add_u32 s35, s31, 419840
    buffer_load_dwordx4 v4, s[16:19], s35 offen lds
    v_mfma_f32_32x32x16_bf16 v[80:95], v[56:59], v[44:47], v[80:95]
    v_mfma_f32_32x32x16_bf16 v[96:111], v[60:63], v[40:43], v[96:111]
    s_add_u32 m0, s34, 52224
    s_add_u32 s35, s31, 424960
    buffer_load_dwordx4 v4, s[16:19], s35 offen lds
    v_mfma_f32_32x32x16_bf16 v[112:127], v[60:63], v[44:47], v[112:127]
    s_waitcnt vmcnt(16)
    s_barrier
    ds_read_b128 v[32:35], v12 offset:32768
    ds_read_b128 v[36:39], v12 offset:36864
    ds_read_b64_tr_b16 v[48:49], v18 offset:49152
    ds_read_b64_tr_b16 v[50:51], v18 offset:50176
    ds_read_b64_tr_b16 v[52:53], v19 offset:49152
    ds_read_b64_tr_b16 v[54:55], v19 offset:50176
    ds_read_b128 v[40:43], v13 offset:32768
    ds_read_b128 v[44:47], v13 offset:36864
    ds_read_b64_tr_b16 v[56:57], v18 offset:53248
    ds_read_b64_tr_b16 v[58:59], v18 offset:54272
    ds_read_b64_tr_b16 v[60:61], v19 offset:53248
    ds_read_b64_tr_b16 v[62:63], v19 offset:54272
    s_waitcnt lgkmcnt(6)
    v_mfma_f32_32x32x16_bf16 v[64:79], v[48:51], v[32:35], v[64:79]
    s_add_u32 m0, s33, 65536
    s_add_u32 s35, s30, 768
    buffer_load_dwordx4 v2, s[12:15], s35 offen lds
    v_mfma_f32_32x32x16_bf16 v[80:95], v[48:51], v[36:39], v[80:95]
    v_mfma_f32_32x32x16_bf16 v[96:111], v[52:55], v[32:35], v[96:111]
    s_add_u32 m0, s33, 66560
    s_add_u32 s35, s30, 11008
    buffer_load_dwordx4 v3, s[12:15], s35 offen lds
    v_mfma_f32_32x32x16_bf16 v[112:127], v[52:55], v[36:39], v[112:127]
    ds_read_b128 v[32:35], v14 offset:32768
    ds_read_b128 v[36:39], v14 offset:36864
    ds_read_b64_tr_b16 v[48:49], v18 offset:57344
    ds_read_b64_tr_b16 v[50:51], v18 offset:58368
    ds_read_b64_tr_b16 v[52:53], v19 offset:57344
    ds_read_b64_tr_b16 v[54:55], v19 offset:58368
    s_waitcnt lgkmcnt(6)
    v_mfma_f32_32x32x16_bf16 v[64:79], v[56:59], v[40:43], v[64:79]
    s_add_u32 m0, s33, 67584
    s_add_u32 s35, s30, 21248
    buffer_load_dwordx4 v2, s[12:15], s35 offen lds
    v_mfma_f32_32x32x16_bf16 v[80:95], v[56:59], v[44:47], v[80:95]
    v_mfma_f32_32x32x16_bf16 v[96:111], v[60:63], v[40:43], v[96:111]
    s_add_u32 m0, s33, 68608
    s_add_u32 s35, s30, 31488
    buffer_load_dwordx4 v3, s[12:15], s35 offen lds
    v_mfma_f32_32x32x16_bf16 v[112:127], v[60:63], v[44:47], v[112:127]
    ds_read_b128 v[40:43], v15 offset:32768
    ds_read_b128 v[44:47], v15 offset:36864
    ds_read_b64_tr_b16 v[56:57], v18 offset:61440
    ds_read_b64_tr_b16 v[58:59], v18 offset:62464
    ds_read_b64_tr_b16 v[60:61], v19 offset:61440
    ds_read_b64_tr_b16 v[62:63], v19 offset:62464
    s_waitcnt lgkmcnt(6)
    v_mfma_f32_32x32x16_bf16 v[64:79], v[48:51], v[32:35], v[64:79]
    s_add_u32 m0, s34, 81920
    s_add_u32 s35, s31, 491520
    buffer_load_dwordx4 v4, s[16:19], s35 offen lds
    v_mfma_f32_32x32x16_bf16 v[80:95], v[48:51], v[36:39], v[80:95]
    v_mfma_f32_32x32x16_bf16 v[96:111], v[52:55], v[32:35], v[96:111]
    s_add_u32 m0, s34, 82944
    s_add_u32 s35, s31, 496640
    buffer_load_dwordx4 v4, s[16:19], s35 offen lds
    v_mfma_f32_32x32x16_bf16 v[112:127], v[52:55], v[36:39], v[112:127]
    s_waitcnt lgkmcnt(0)
    v_mfma_f32_32x32x16_bf16 v[64:79], v[56:59], v[40:43], v[64:79]
    s_add_u32 m0, s34, 83968
    s_add_u32 s35, s31, 501760
    buffer_load_dwordx4 v4, s[16:19], s35 offen lds
    v_mfma_f32_32x32x16_bf16 v[80:95], v[56:59], v[44:47], v[80:95]
    v_mfma_f32_32x32x16_bf16 v[96:111], v[60:63], v[40:43], v[96:111]
    s_add_u32 m0, s34, 84992
    s_add_u32 s35, s31, 506880
    buffer_load_dwordx4 v4, s[16:19], s35 offen lds
    v_mfma_f32_32x32x16_bf16 v[112:127], v[60:63], v[44:47], v[112:127]
    s_waitcnt vmcnt(16)
    s_barrier
    ds_read_b128 v[32:35], v8
    ds_read_b128 v[36:39], v8 offset:4096
    ds_read_b64_tr_b16 v[48:49], v16 offset:16384
    ds_read_b64_tr_b16 v[50:51], v16 offset:17408
    ds_read_b64_tr_b16 v[52:53], v17 offset:16384
    ds_read_b64_tr_b16 v[54:55], v17 offset:17408
    ds_read_b128 v[40:43], v9
    ds_read_b128 v[44:47], v9 offset:4096
    ds_read_b64_tr_b16 v[56:57], v16 offset:20480
    ds_read_b64_tr_b16 v[58:59], v16 offset:21504
    ds_read_b64_tr_b16 v[60:61], v17 offset:20480
    ds_read_b64_tr_b16 v[62:63], v17 offset:21504
    s_waitcnt lgkmcnt(6)
    v_mfma_f32_32x32x16_bf16 v[64:79], v[48:51], v[32:35], v[64:79]
    s_add_u32 m0, s33, 98304
    s_add_u32 s35, s30, 896
    buffer_load_dwordx4 v2, s[12:15], s35 offen lds
    v_mfma_f32_32x32x16_bf16 v[80:95], v[48:51], v[36:39], v[80:95]
    v_mfma_f32_32x32x16_bf16 v[96:111], v[52:55], v[32:35], v[96:111]
    s_add_u32 m0, s33, 99328
    s_add_u32 s35, s30, 11136
    buffer_load_dwordx4 v3, s[12:15], s35 offen lds
    v_mfma_f32_32x32x16_bf16 v[112:127], v[52:55], v[36:39], v[112:127]
    ds_read_b128 v[32:35], v10
    ds_read_b128 v[36:39], v10 offset:4096
    ds_read_b64_tr_b16 v[48:49], v16 offset:24576
    ds_read_b64_tr_b16 v[50:51], v16 offset:25600
    ds_read_b64_tr_b16 v[52:53], v17 offset:24576
    ds_read_b64_tr_b16 v[54:55], v17 offset:25600
    s_waitcnt lgkmcnt(6)
    v_mfma_f32_32x32x16_bf16 v[64:79], v[56:59], v[40:43], v[64:79]
    s_add_u32 m0, s33, 100352
    s_add_u32 s35, s30, 21376
    buffer_load_dwordx4 v2, s[12:15], s35 offen lds
    v_mfma_f32_32x32x16_bf16 v[80:95], v[56:59], v[44:47], v[80:95]
    v_mfma_f32_32x32x16_bf16 v[96:111], v[60:63], v[40:43], v[96:111]
    s_add_u32 m0, s33, 101376
    s_add_u32 s35, s30, 31616
    buffer_load_dwordx4 v3, s[12:15], s35 offen lds
    v_mfma_f32_32x32x16_bf16 v[112:127], v[60:63], v[44:47], v[112:127]
    ds_read_b128 v[40:43], v11
    ds_read_b128 v[44:47], v11 offset:4096
    ds_read_b64_tr_b16 v[56:57], v16 offset:28672
    ds_read_b64_tr_b16 v[58:59], v16 offset:29696
    ds_read_b64_tr_b16 v[60:61], v17 offset:28672
    ds_read_b64_tr_b16 v[62:63], v17 offset:29696
    s_waitcnt lgkmcnt(6)
    v_mfma_f32_32x32x16_bf16 v[64:79], v[48:51], v[32:35], v[64:79]
    s_add_u32 m0, s34, 114688
    s_add_u32 s35, s31, 573440
    buffer_load_dwordx4 v4, s[16:19], s35 offen lds
    v_mfma_f32_32x32x16_bf16 v[80:95], v[48:51], v[36:39], v[80:95]
    v_mfma_f32_32x32x16_bf16 v[96:111], v[52:55], v[32:35], v[96:111]
    s_add_u32 m0, s34, 115712
    s_add_u32 s35, s31, 578560
    buffer_load_dwordx4 v4, s[16:19], s35 offen lds
    v_mfma_f32_32x32x16_bf16 v[112:127], v[52:55], v[36:39], v[112:127]
    s_waitcnt lgkmcnt(0)
    v_mfma_f32_32x32x16_bf16 v[64:79], v[56:59], v[40:43], v[64:79]
    s_add_u32 m0, s34, 116736
    s_add_u32 s35, s31, 583680
    buffer_load_dwordx4 v4, s[16:19], s35 offen lds
    v_mfma_f32_32x32x16_bf16 v[80:95], v[56:59], v[44:47], v[80:95]
    v_mfma_f32_32x32x16_bf16 v[96:111], v[60:63], v[40:43], v[96:111]
    s_add_u32 m0, s34, 117760
    s_add_u32 s35, s31, 588800
    buffer_load_dwordx4 v4, s[16:19], s35 offen lds
    v_mfma_f32_32x32x16_bf16 v[112:127], v[60:63], v[44:47], v[112:127]
    s_waitcnt vmcnt(16)
    s_barrier
    ds_read_b128 v[32:35], v8 offset:32768
    ds_read_b128 v[36:39], v8 offset:36864
    ds_read_b64_tr_b16 v[48:49], v16 offset:49152
    ds_read_b64_tr_b16 v[50:51], v16 offset:50176
    ds_read_b64_tr_b16 v[52:53], v17 offset:49152
    ds_read_b64_tr_b16 v[54:55], v17 offset:50176
    ds_read_b128 v[40:43], v9 offset:32768
    ds_read_b128 v[44:47], v9 offset:36864
    ds_read_b64_tr_b16 v[56:57], v16 offset:53248
    ds_read_b64_tr_b16 v[58:59], v16 offset:54272
    ds_read_b64_tr_b16 v[60:61], v17 offset:53248
    ds_read_b64_tr_b16 v[62:63], v17 offset:54272
    s_waitcnt lgkmcnt(6)
    v_mfma_f32_32x32x16_bf16 v[64:79], v[48:51], v[32:35], v[64:79]
    s_add_u32 m0, s33, 0
    s_add_u32 s35, s30, 1024
    buffer_load_dwordx4 v2, s[12:15], s35 offen lds
    v_mfma_f32_32x32x16_bf16 v[80:95], v[48:51], v[36:39], v[80:95]
    v_mfma_f32_32x32x16_bf16 v[96:111], v[52:55], v[32:35], v[96:111]
    s_add_u32 m0, s33, 1024
    s_add_u32 s35, s30, 11264
    buffer_load_dwordx4 v3, s[12:15], s35 offen lds
    v_mfma_f32_32x32x16_bf16 v[112:127], v[52:55], v[36:39], v[112:127]
    ds_read_b128 v[32:35], v10 offset:32768
    ds_read_b128 v[36:39], v10 offset:36864
    ds_read_b64_tr_b16 v[48:49], v16 offset:57344
    ds_read_b64_tr_b16 v[50:51], v16 offset:58368
    ds_read_b64_tr_b16 v[52:53], v17 offset:57344
    ds_read_b64_tr_b16 v[54:55], v17 offset:58368
    s_waitcnt lgkmcnt(6)
    v_mfma_f32_32x32x16_bf16 v[64:79], v[56:59], v[40:43], v[64:79]
    s_add_u32 m0, s33, 2048
    s_add_u32 s35, s30, 21504
    buffer_load_dwordx4 v2, s[12:15], s35 offen lds
    v_mfma_f32_32x32x16_bf16 v[80:95], v[56:59], v[44:47], v[80:95]
    v_mfma_f32_32x32x16_bf16 v[96:111], v[60:63], v[40:43], v[96:111]
    s_add_u32 m0, s33, 3072
    s_add_u32 s35, s30, 31744
    buffer_load_dwordx4 v3, s[12:15], s35 offen lds
    v_mfma_f32_32x32x16_bf16 v[112:127], v[60:63], v[44:47], v[112:127]
    ds_read_b128 v[40:43], v11 offset:32768
    ds_read_b128 v[44:47], v11 offset:36864
    ds_read_b64_tr_b16 v[56:57], v16 offset:61440
    ds_read_b64_tr_b16 v[58:59], v16 offset:62464
    ds_read_b64_tr_b16 v[60:61], v17 offset:61440
    ds_read_b64_tr_b16 v[62:63], v17 offset:62464
    s_waitcnt lgkmcnt(6)
    v_mfma_f32_32x32x16_bf16 v[64:79], v[48:51], v[32:35], v[64:79]
    s_add_u32 m0, s34, 16384
    s_add_u32 s35, s31, 655360
    buffer_load_dwordx4 v4, s[16:19], s35 offen lds
    v_mfma_f32_32x32x16_bf16 v[80:95], v[48:51], v[36:39], v[80:95]
    v_mfma_f32_32x32x16_bf16 v[96:111], v[52:55], v[32:35], v[96:111]
    s_add_u32 m0, s34, 17408
    s_add_u32 s35, s31, 660480
    buffer_load_dwordx4 v4, s[16:19], s35 offen lds
    v_mfma_f32_32x32x16_bf16 v[112:127], v[52:55], v[36:39], v[112:127]
    s_waitcnt lgkmcnt(0)
    v_mfma_f32_32x32x16_bf16 v[64:79], v[56:59], v[40:43], v[64:79]
    s_add_u32 m0, s34, 18432
    s_add_u32 s35, s31, 665600
    buffer_load_dwordx4 v4, s[16:19], s35 offen lds
    v_mfma_f32_32x32x16_bf16 v[80:95], v[56:59], v[44:47], v[80:95]
    v_mfma_f32_32x32x16_bf16 v[96:111], v[60:63], v[40:43], v[96:111]
    s_add_u32 m0, s34, 19456
    s_add_u32 s35, s31, 670720
    buffer_load_dwordx4 v4, s[16:19], s35 offen lds
    v_mfma_f32_32x32x16_bf16 v[112:127], v[60:63], v[44:47], v[112:127]
    s_waitcnt vmcnt(16)
    s_barrier
    ds_read_b128 v[32:35], v12
    ds_read_b128 v[36:39], v12 offset:4096
    ds_read_b64_tr_b16 v[48:49], v18 offset:16384
    ds_read_b64_tr_b16 v[50:51], v18 offset:17408
    ds_read_b64_tr_b16 v[52:53], v19 offset:16384
    ds_read_b64_tr_b16 v[54:55], v19 offset:17408
    ds_read_b128 v[40:43], v13
    ds_read_b128 v[44:47], v13 offset:4096
    ds_read_b64_tr_b16 v[56:57], v18 offset:20480
    ds_read_b64_tr_b16 v[58:59], v18 offset:21504
    ds_read_b64_tr_b16 v[60:61], v19 offset:20480
    ds_read_b64_tr_b16 v[62:63], v19 offset:21504
    s_waitcnt lgkmcnt(6)
    v_mfma_f32_32x32x16_bf16 v[64:79], v[48:51], v[32:35], v[64:79]
    s_add_u32 m0, s33, 32768
    s_add_u32 s35, s30, 1152
    buffer_load_dwordx4 v2, s[12:15], s35 offen lds
    v_mfma_f32_32x32x16_bf16 v[80:95], v[48:51], v[36:39], v[80:95]
    v_mfma_f32_32x32x16_bf16 v[96:111], v[52:55], v[32:35], v[96:111]
    s_add_u32 m0, s33, 33792
    s_add_u32 s35, s30, 11392
    buffer_load_dwordx4 v3, s[12:15], s35 offen lds
    v_mfma_f32_32x32x16_bf16 v[112:127], v[52:55], v[36:39], v[112:127]
    ds_read_b128 v[32:35], v14
    ds_read_b128 v[36:39], v14 offset:4096
    ds_read_b64_tr_b16 v[48:49], v18 offset:24576
    ds_read_b64_tr_b16 v[50:51], v18 offset:25600
    ds_read_b64_tr_b16 v[52:53], v19 offset:24576
    ds_read_b64_tr_b16 v[54:55], v19 offset:25600
    s_waitcnt lgkmcnt(6)
    v_mfma_f32_32x32x16_bf16 v[64:79], v[56:59], v[40:43], v[64:79]
    s_add_u32 m0, s33, 34816
    s_add_u32 s35, s30, 21632
    buffer_load_dwordx4 v2, s[12:15], s35 offen lds
    v_mfma_f32_32x32x16_bf16 v[80:95], v[56:59], v[44:47], v[80:95]
    v_mfma_f32_32x32x16_bf16 v[96:111], v[60:63], v[40:43], v[96:111]
    s_add_u32 m0, s33, 35840
    s_add_u32 s35, s30, 31872
    buffer_load_dwordx4 v3, s[12:15], s35 offen lds
    v_mfma_f32_32x32x16_bf16 v[112:127], v[60:63], v[44:47], v[112:127]
    ds_read_b128 v[40:43], v15
    ds_read_b128 v[44:47], v15 offset:4096
    ds_read_b64_tr_b16 v[56:57], v18 offset:28672
    ds_read_b64_tr_b16 v[58:59], v18 offset:29696
    ds_read_b64_tr_b16 v[60:61], v19 offset:28672
    ds_read_b64_tr_b16 v[62:63], v19 offset:29696
    s_waitcnt lgkmcnt(6)
    v_mfma_f32_32x32x16_bf16 v[64:79], v[48:51], v[32:35], v[64:79]
    s_add_u32 m0, s34, 49152
    s_add_u32 s35, s31, 737280
    buffer_load_dwordx4 v4, s[16:19], s35 offen lds
    v_mfma_f32_32x32x16_bf16 v[80:95], v[48:51], v[36:39], v[80:95]
    v_mfma_f32_32x32x16_bf16 v[96:111], v[52:55], v[32:35], v[96:111]
    s_add_u32 m0, s34, 50176
    s_add_u32 s35, s31, 742400
    buffer_load_dwordx4 v4, s[16:19], s35 offen lds
    v_mfma_f32_32x32x16_bf16 v[112:127], v[52:55], v[36:39], v[112:127]
    s_waitcnt lgkmcnt(0)
    v_mfma_f32_32x32x16_bf16 v[64:79], v[56:59], v[40:43], v[64:79]
    s_add_u32 m0, s34, 51200
    s_add_u32 s35, s31, 747520
    buffer_load_dwordx4 v4, s[16:19], s35 offen lds
    v_mfma_f32_32x32x16_bf16 v[80:95], v[56:59], v[44:47], v[80:95]
    v_mfma_f32_32x32x16_bf16 v[96:111], v[60:63], v[40:43], v[96:111]
    s_add_u32 m0, s34, 52224
    s_add_u32 s35, s31, 752640
    buffer_load_dwordx4 v4, s[16:19], s35 offen lds
    v_mfma_f32_32x32x16_bf16 v[112:127], v[60:63], v[44:47], v[112:127]
    s_waitcnt vmcnt(16)
    s_barrier
    ds_read_b128 v[32:35], v12 offset:32768
    ds_read_b128 v[36:39], v12 offset:36864
    ds_read_b64_tr_b16 v[48:49], v18 offset:49152
    ds_read_b64_tr_b16 v[50:51], v18 offset:50176
    ds_read_b64_tr_b16 v[52:53], v19 offset:49152
    ds_read_b64_tr_b16 v[54:55], v19 offset:50176
    ds_read_b128 v[40:43], v13 offset:32768
    ds_read_b128 v[44:47], v13 offset:36864
    ds_read_b64_tr_b16 v[56:57], v18 offset:53248
    ds_read_b64_tr_b16 v[58:59], v18 offset:54272
    ds_read_b64_tr_b16 v[60:61], v19 offset:53248
    ds_read_b64_tr_b16 v[62:63], v19 offset:54272
    s_waitcnt lgkmcnt(6)
    v_mfma_f32_32x32x16_bf16 v[64:79], v[48:51], v[32:35], v[64:79]
    v_mfma_f32_32x32x16_bf16 v[80:95], v[48:51], v[36:39], v[80:95]
    v_mfma_f32_32x32x16_bf16 v[96:111], v[52:55], v[32:35], v[96:111]
    v_mfma_f32_32x32x16_bf16 v[112:127], v[52:55], v[36:39], v[112:127]
    ds_read_b128 v[32:35], v14 offset:32768
    ds_read_b128 v[36:39], v14 offset:36864
    ds_read_b64_tr_b16 v[48:49], v18 offset:57344
    ds_read_b64_tr_b16 v[50:51], v18 offset:58368
    ds_read_b64_tr_b16 v[52:53], v19 offset:57344
    ds_read_b64_tr_b16 v[54:55], v19 offset:58368
    s_waitcnt lgkmcnt(6)
    v_mfma_f32_32x32x16_bf16 v[64:79], v[56:59], v[40:43], v[64:79]
    v_mfma_f32_32x32x16_bf16 v[80:95], v[56:59], v[44:47], v[80:95]
    v_mfma_f32_32x32x16_bf16 v[96:111], v[60:63], v[40:43], v[96:111]
    v_mfma_f32_32x32x16_bf16 v[112:127], v[60:63], v[44:47], v[112:127]
    ds_read_b128 v[40:43], v15 offset:32768
    ds_read_b128 v[44:47], v15 offset:36864
    ds_read_b64_tr_b16 v[56:57], v18 offset:61440
    ds_read_b64_tr_b16 v[58:59], v18 offset:62464
    ds_read_b64_tr_b16 v[60:61], v19 offset:61440
    ds_read_b64_tr_b16 v[62:63], v19 offset:62464
    s_waitcnt lgkmcnt(6)
    v_mfma_f32_32x32x16_bf16 v[64:79], v[48:51], v[32:35], v[64:79]
    v_mfma_f32_32x32x16_bf16 v[80:95], v[48:51], v[36:39], v[80:95]
    v_mfma_f32_32x32x16_bf16 v[96:111], v[52:55], v[32:35], v[96:111]
    v_mfma_f32_32x32x16_bf16 v[112:127], v[52:55], v[36:39], v[112:127]
    s_waitcnt lgkmcnt(0)
    v_mfma_f32_32x32x16_bf16 v[64:79], v[56:59], v[40:43], v[64:79]
    v_mfma_f32_32x32x16_bf16 v[80:95], v[56:59], v[44:47], v[80:95]
    v_mfma_f32_32x32x16_bf16 v[96:111], v[60:63], v[40:43], v[96:111]
    v_mfma_f32_32x32x16_bf16 v[112:127], v[60:63], v[44:47], v[112:127]
    s_waitcnt vmcnt(8)
    s_barrier
    ds_read_b128 v[32:35], v8
    ds_read_b128 v[36:39], v8 offset:4096
    ds_read_b64_tr_b16 v[48:49], v16 offset:16384
    ds_read_b64_tr_b16 v[50:51], v16 offset:17408
    ds_read_b64_tr_b16 v[52:53], v17 offset:16384
    ds_read_b64_tr_b16 v[54:55], v17 offset:17408
    ds_read_b128 v[40:43], v9
    ds_read_b128 v[44:47], v9 offset:4096
    ds_read_b64_tr_b16 v[56:57], v16 offset:20480
    ds_read_b64_tr_b16 v[58:59], v16 offset:21504
    ds_read_b64_tr_b16 v[60:61], v17 offset:20480
    ds_read_b64_tr_b16 v[62:63], v17 offset:21504
    s_waitcnt lgkmcnt(6)
    v_mfma_f32_32x32x16_bf16 v[64:79], v[48:51], v[32:35], v[64:79]
    v_mfma_f32_32x32x16_bf16 v[80:95], v[48:51], v[36:39], v[80:95]
    v_mfma_f32_32x32x16_bf16 v[96:111], v[52:55], v[32:35], v[96:111]
    v_mfma_f32_32x32x16_bf16 v[112:127], v[52:55], v[36:39], v[112:127]
    ds_read_b128 v[32:35], v10
    ds_read_b128 v[36:39], v10 offset:4096
    ds_read_b64_tr_b16 v[48:49], v16 offset:24576
    ds_read_b64_tr_b16 v[50:51], v16 offset:25600
    ds_read_b64_tr_b16 v[52:53], v17 offset:24576
    ds_read_b64_tr_b16 v[54:55], v17 offset:25600
    s_waitcnt lgkmcnt(6)
    v_mfma_f32_32x32x16_bf16 v[64:79], v[56:59], v[40:43], v[64:79]
    v_mfma_f32_32x32x16_bf16 v[80:95], v[56:59], v[44:47], v[80:95]
    v_mfma_f32_32x32x16_bf16 v[96:111], v[60:63], v[40:43], v[96:111]
    v_mfma_f32_32x32x16_bf16 v[112:127], v[60:63], v[44:47], v[112:127]
    ds_read_b128 v[40:43], v11
    ds_read_b128 v[44:47], v11 offset:4096
    ds_read_b64_tr_b16 v[56:57], v16 offset:28672
    ds_read_b64_tr_b16 v[58:59], v16 offset:29696
    ds_read_b64_tr_b16 v[60:61], v17 offset:28672
    ds_read_b64_tr_b16 v[62:63], v17 offset:29696
    s_waitcnt lgkmcnt(6)
    v_mfma_f32_32x32x16_bf16 v[64:79], v[48:51], v[32:35], v[64:79]
    v_mfma_f32_32x32x16_bf16 v[80:95], v[48:51], v[36:39], v[80:95]
    v_mfma_f32_32x32x16_bf16 v[96:111], v[52:55], v[32:35], v[96:111]
    v_mfma_f32_32x32x16_bf16 v[112:127], v[52:55], v[36:39], v[112:127]
    s_waitcnt lgkmcnt(0)
    v_mfma_f32_32x32x16_bf16 v[64:79], v[56:59], v[40:43], v[64:79]
    v_mfma_f32_32x32x16_bf16 v[80:95], v[56:59], v[44:47], v[80:95]
    v_mfma_f32_32x32x16_bf16 v[96:111], v[60:63], v[40:43], v[96:111]
    v_mfma_f32_32x32x16_bf16 v[112:127], v[60:63], v[44:47], v[112:127]
    s_waitcnt vmcnt(0)
    s_barrier
    ds_read_b128 v[32:35], v8 offset:32768
    ds_read_b128 v[36:39], v8 offset:36864
    ds_read_b64_tr_b16 v[48:49], v16 offset:49152
    ds_read_b64_tr_b16 v[50:51], v16 offset:50176
    ds_read_b64_tr_b16 v[52:53], v17 offset:49152
    ds_read_b64_tr_b16 v[54:55], v17 offset:50176
    ds_read_b128 v[40:43], v9 offset:32768
    ds_read_b128 v[44:47], v9 offset:36864
    ds_read_b64_tr_b16 v[56:57], v16 offset:53248
    ds_read_b64_tr_b16 v[58:59], v16 offset:54272
    ds_read_b64_tr_b16 v[60:61], v17 offset:53248
    ds_read_b64_tr_b16 v[62:63], v17 offset:54272
    s_waitcnt lgkmcnt(6)
    v_mfma_f32_32x32x16_bf16 v[64:79], v[48:51], v[32:35], v[64:79]
    v_mfma_f32_32x32x16_bf16 v[80:95], v[48:51], v[36:39], v[80:95]
    v_mfma_f32_32x32x16_bf16 v[96:111], v[52:55], v[32:35], v[96:111]
    v_mfma_f32_32x32x16_bf16 v[112:127], v[52:55], v[36:39], v[112:127]
    ds_read_b128 v[32:35], v10 offset:32768
    ds_read_b128 v[36:39], v10 offset:36864
    ds_read_b64_tr_b16 v[48:49], v16 offset:57344
    ds_read_b64_tr_b16 v[50:51], v16 offset:58368
    ds_read_b64_tr_b16 v[52:53], v17 offset:57344
    ds_read_b64_tr_b16 v[54:55], v17 offset:58368
    s_waitcnt lgkmcnt(6)
    v_mfma_f32_32x32x16_bf16 v[64:79], v[56:59], v[40:43], v[64:79]
    v_mfma_f32_32x32x16_bf16 v[80:95], v[56:59], v[44:47], v[80:95]
    v_mfma_f32_32x32x16_bf16 v[96:111], v[60:63], v[40:43], v[96:111]
    v_mfma_f32_32x32x16_bf16 v[112:127], v[60:63], v[44:47], v[112:127]
    ds_read_b128 v[40:43], v11 offset:32768
    ds_read_b128 v[44:47], v11 offset:36864
    ds_read_b64_tr_b16 v[56:57], v16 offset:61440
    ds_read_b64_tr_b16 v[58:59], v16 offset:62464
    ds_read_b64_tr_b16 v[60:61], v17 offset:61440
    ds_read_b64_tr_b16 v[62:63], v17 offset:62464
    s_waitcnt lgkmcnt(6)
    v_mfma_f32_32x32x16_bf16 v[64:79], v[48:51], v[32:35], v[64:79]
    v_mfma_f32_32x32x16_bf16 v[80:95], v[48:51], v[36:39], v[80:95]
    v_mfma_f32_32x32x16_bf16 v[96:111], v[52:55], v[32:35], v[96:111]
    v_mfma_f32_32x32x16_bf16 v[112:127], v[52:55], v[36:39], v[112:127]
    s_waitcnt lgkmcnt(0)
    v_mfma_f32_32x32x16_bf16 v[64:79], v[56:59], v[40:43], v[64:79]
    v_mfma_f32_32x32x16_bf16 v[80:95], v[56:59], v[44:47], v[80:95]
    v_mfma_f32_32x32x16_bf16 v[96:111], v[60:63], v[40:43], v[96:111]
    v_mfma_f32_32x32x16_bf16 v[112:127], v[60:63], v[44:47], v[112:127]
    s_nop 15
    s_nop 15
    s_mov_b32 s40, s10
    s_mov_b32 s41, s11
    s_mov_b32 s42, 2621440
    s_mov_b32 s43, 0x00020000
    s_lshr_b32 s36, s20, 1
    s_lshl_b32 s36, s36, 6
    s_lshl_b32 s37, s24, 7
    s_add_u32 s36, s36, s37
    v_and_b32 v20, 31, v1
    v_add_u32 v20, s36, v20
    v_lshrrev_b32 v21, 5, v1
    v_lshlrev_b32 v21, 3, v21
    s_and_b32 s36, s20, 1
    s_lshl_b32 s36, s36, 7
    s_lshl_b32 s37, s25, 8
    s_add_u32 s36, s36, s37
    v_add_u32 v22, 0, v20
    v_mul_u32_u24 v22, 1280, v22
    v_add_u32 v22, v22, v21
    v_add_u32 v23, 32, v20
    v_mul_u32_u24 v23, 1280, v23
    v_add_u32 v23, v23, v21
    v_cvt_pk_bf16_f32 v64, v64, v65
    v_cvt_pk_bf16_f32 v65, v66, v67
    buffer_store_dwordx2 v[64:65], v22, s[40:43], s36 offen
    v_cvt_pk_bf16_f32 v68, v68, v69
    v_cvt_pk_bf16_f32 v69, v70, v71
    buffer_store_dwordx2 v[68:69], v22, s[40:43], s36 offen offset:16
    v_cvt_pk_bf16_f32 v72, v72, v73
    v_cvt_pk_bf16_f32 v73, v74, v75
    buffer_store_dwordx2 v[72:73], v22, s[40:43], s36 offen offset:32
    v_cvt_pk_bf16_f32 v76, v76, v77
    v_cvt_pk_bf16_f32 v77, v78, v79
    buffer_store_dwordx2 v[76:77], v22, s[40:43], s36 offen offset:48
    v_cvt_pk_bf16_f32 v80, v80, v81
    v_cvt_pk_bf16_f32 v81, v82, v83
    buffer_store_dwordx2 v[80:81], v23, s[40:43], s36 offen
    v_cvt_pk_bf16_f32 v84, v84, v85
    v_cvt_pk_bf16_f32 v85, v86, v87
    buffer_store_dwordx2 v[84:85], v23, s[40:43], s36 offen offset:16
    v_cvt_pk_bf16_f32 v88, v88, v89
    v_cvt_pk_bf16_f32 v89, v90, v91
    buffer_store_dwordx2 v[88:89], v23, s[40:43], s36 offen offset:32
    v_cvt_pk_bf16_f32 v92, v92, v93
    v_cvt_pk_bf16_f32 v93, v94, v95
    buffer_store_dwordx2 v[92:93], v23, s[40:43], s36 offen offset:48
    v_cvt_pk_bf16_f32 v96, v96, v97
    v_cvt_pk_bf16_f32 v97, v98, v99
    buffer_store_dwordx2 v[96:97], v22, s[40:43], s36 offen offset:64
    v_cvt_pk_bf16_f32 v100, v100, v101
    v_cvt_pk_bf16_f32 v101, v102, v103
    buffer_store_dwordx2 v[100:101], v22, s[40:43], s36 offen offset:80
    v_cvt_pk_bf16_f32 v104, v104, v105
    v_cvt_pk_bf16_f32 v105, v106, v107
    buffer_store_dwordx2 v[104:105], v22, s[40:43], s36 offen offset:96
    v_cvt_pk_bf16_f32 v108, v108, v109
    v_cvt_pk_bf16_f32 v109, v110, v111
    buffer_store_dwordx2 v[108:109], v22, s[40:43], s36 offen offset:112
    v_cvt_pk_bf16_f32 v112, v112, v113
    v_cvt_pk_bf16_f32 v113, v114, v115
    buffer_store_dwordx2 v[112:113], v23, s[40:43], s36 offen offset:64
    v_cvt_pk_bf16_f32 v116, v116, v117
    v_cvt_pk_bf16_f32 v117, v118, v119
    buffer_store_dwordx2 v[116:117], v23, s[40:43], s36 offen offset:80
    v_cvt_pk_bf16_f32 v120, v120, v121
    v_cvt_pk_bf16_f32 v121, v122, v123
    buffer_store_dwordx2 v[120:121], v23, s[40:43], s36 offen offset:96
    v_cvt_pk_bf16_f32 v124, v124, v125
    v_cvt_pk_bf16_f32 v125, v126, v127
    buffer_store_dwordx2 v[124:125], v23, s[40:43], s36 offen offset:112
L_mha_oproj_kernel_end:
    s_endpgm
.section .rodata,"a"
.p2align 6
.amdhsa_kernel mha_qkv_kernel
  .amdhsa_next_free_vgpr 128
  .amdhsa_next_free_sgpr 96
  .amdhsa_accum_offset 128
  .amdhsa_group_segment_fixed_size 0
  .amdhsa_kernarg_size 48
  .amdhsa_user_sgpr_count 2
  .amdhsa_user_sgpr_kernarg_segment_ptr 1
  .amdhsa_system_sgpr_workgroup_id_x 1
.end_amdhsa_kernel
.p2align 6
.amdhsa_kernel mha_attn_kernel
  .amdhsa_next_free_vgpr 152
  .amdhsa_next_free_sgpr 96
  .amdhsa_accum_offset 152
  .amdhsa_group_segment_fixed_size 0
  .amdhsa_kernarg_size 48
  .amdhsa_user_sgpr_count 2
  .amdhsa_user_sgpr_kernarg_segment_ptr 1
  .amdhsa_system_sgpr_workgroup_id_x 1
.end_amdhsa_kernel
.p2align 6
.amdhsa_kernel mha_oproj_kernel
  .amdhsa_next_free_vgpr 128
  .amdhsa_next_free_sgpr 96
  .amdhsa_accum_offset 128
  .amdhsa_group_segment_fixed_size 0
  .amdhsa_kernarg_size 48
  .amdhsa_user_sgpr_count 2
  .amdhsa_user_sgpr_kernarg_segment_ptr 1
  .amdhsa_system_sgpr_workgroup_id_x 1
.end_amdhsa_kernel
```
